```python
import torch

def _softmax(x, axis=-1):
    return torch.softmax(x, dim=axis)
def _gelu(x):
    return torch.nn.functional.gelu(x, approximate="tanh")
def _silu(x):
    return torch.nn.functional.silu(x)
def _sigmoid(x):
    return torch.sigmoid(x)
def _layernorm(x, axis=-1, eps=1e-5):
    m = x.mean(dim=axis, keepdim=True)
    v = x.var(dim=axis, keepdim=True, unbiased=False)
    return (x - m) / torch.sqrt(v + eps)
def _scatter_add(tgt, idx, src, axis=0):
    return tgt.clone().index_add_(axis, idx, src)
def _segment_sum(src, seg, n):
    out = torch.zeros((n,) + src.shape[1:], dtype=src.dtype)
    return out.index_add_(0, seg, src)
def _pad(x, pw):
    flat = tuple(v for pair in reversed(pw) for v in pair)
    return torch.nn.functional.pad(x, flat)

kernel_name = 'concat_heads__gqa_block_cached__mha_block_cached__near_ridge'

def setup_inputs():

    _w = (lambda a: (lambda t: t.to(torch.bfloat16) if t.is_floating_point() else t)(torch.as_tensor(a)))
    def _A_setup():
        B, Sq, D = 32, 32, 448
        Hq, Hkv, Sk, Dh = 16, 8, 32, 256
        assert Hq % Hkv == 0, (Hq, Hkv)
        return {
            "x": _w((lambda *s: torch.randn(*s, dtype=torch.bfloat16) * 0.8)(B, Sq, D)),
            "k_cache": _w((lambda *s: torch.randn(*s, dtype=torch.bfloat16) * 0.8)(B, Hkv, Sk, Dh)),
            "v_cache": _w((lambda *s: torch.randn(*s, dtype=torch.bfloat16) * 0.05)(B, Hkv, Sk, Dh)),
            "wq": _w((lambda *s: torch.randn(*s, dtype=torch.bfloat16) * 0.8)(D, Hq * Dh) * (D ** -0.5)),
            "wo": _w((lambda *s: torch.randn(*s, dtype=torch.bfloat16) * 0.05)(Hq * Dh, D) * ((Hq * Dh) ** -0.5)),
        }
    _A_in = _A_setup()

    def _B_setup():
        B, Sq, D = 32, 32, 448
        H, Sk, Dh = 16, 32, 256
        return {
            "x": _w((lambda *s: torch.randn(*s, dtype=torch.bfloat16) * 0.8)(B, Sq, D)),
            "k_cache": _w((lambda *s: torch.randn(*s, dtype=torch.bfloat16) * 0.8)(B, H, Sk, Dh)),
            "v_cache": _w((lambda *s: torch.randn(*s, dtype=torch.bfloat16) * 0.05)(B, H, Sk, Dh)),
            "wq": _w((lambda *s: torch.randn(*s, dtype=torch.bfloat16) * 0.8)(D, H * Dh) * (D ** -0.5)),
            "wo": _w((lambda *s: torch.randn(*s, dtype=torch.bfloat16) * 0.05)(H * Dh, D) * ((H * Dh) ** -0.5)),
        }
    _B_in = _B_setup()

    return {
        "A_x": _A_in["x"],
        "A_k_cache": _A_in["k_cache"],
        "A_v_cache": _A_in["v_cache"],
        "A_wq": _A_in["wq"],
        "A_wo": _A_in["wo"],
        "B_x": _B_in["x"],
        "B_k_cache": _B_in["k_cache"],
        "B_v_cache": _B_in["v_cache"],
        "B_wq": _B_in["wq"],
        "B_wo": _B_in["wo"],
    }

def reference(A_x, A_k_cache, A_v_cache, A_wq, A_wo, B_x, B_k_cache, B_v_cache, B_wq, B_wo):
    def _A_ref(x, k_cache, v_cache, wq, wo):
        B, Sq, D = x.shape
        Hq, Dh = 16, 256
        Hkv = k_cache.shape[1]
        rep = Hq // Hkv
        q = (lambda x, *d: x.permute(*d))((x @ wq).reshape(B, Sq, Hq, Dh), 0, 2, 1, 3)
        k = (lambda x, n, axis: torch.repeat_interleave(x, n, dim=axis))(k_cache, rep, axis=1)
        v = (lambda x, n, axis: torch.repeat_interleave(x, n, dim=axis))(v_cache, rep, axis=1)
        scores = torch.einsum("bhqd,bhkd->bhqk", q, k) * (Dh ** -0.5)
        p = _softmax(scores, axis=-1)
        o = torch.einsum("bhqk,bhkd->bhqd", p, v)
        return (lambda x, *d: x.permute(*d))(o, 0, 2, 1, 3).reshape(B, Sq, Hq * Dh) @ wo

    def _B_ref(x, k_cache, v_cache, wq, wo):
        B, Sq, D = x.shape
        H, Dh = 16, 256
        q = (lambda x, *d: x.permute(*d))((x @ wq).reshape(B, Sq, H, Dh), 0, 2, 1, 3)
        scores = torch.einsum("bhqd,bhkd->bhqk", q, k_cache) * (Dh ** -0.5)
        p = _softmax(scores, axis=-1)
        o = torch.einsum("bhqk,bhkd->bhqd", p, v_cache)
        return (lambda x, *d: x.permute(*d))(o, 0, 2, 1, 3).reshape(B, Sq, H * Dh) @ wo

    a = _A_ref(A_x, A_k_cache, A_v_cache, A_wq, A_wo)
    b = _B_ref(B_x, B_k_cache, B_v_cache, B_wq, B_wo)
    return torch.concatenate([a, b], axis=-1)
```

```asm
; @launch grid=(256,1,1) block=(256,1,1) lds=163840
.amdgcn_target "amdgcn-amd-amdhsa--gfx950"
.text
.globl concat_heads__gqa_block_cached__mha_block_cached__near_ridge_kernel
.p2align 8
.type concat_heads__gqa_block_cached__mha_block_cached__near_ridge_kernel,@function
concat_heads__gqa_block_cached__mha_block_cached__near_ridge_kernel:
    s_cmp_ge_u32 s2, 0x100
    s_cbranch_scc1 L_end
    s_load_dwordx16 s[8:23], s[0:1], 0
    s_load_dwordx8 s[24:31], s[0:1], 64
    s_load_dwordx2 s[32:33], s[0:1], 96
    v_and_b32 v1, 63, v0
    v_lshrrev_b32 v42, 6, v0
    s_and_b32 s71, s2, 3
    v_readfirstlane_b32 s68, v42
    s_bfe_u32 s72, s2, 0x10002
    s_xor_b32 s72, s72, 1
    s_bfe_u32 s70, s2, 0x20003
    s_lshr_b32 s69, s2, 5
    v_lshrrev_b32 v42, 4, v1
    v_and_b32 v43, 15, v1
    v_lshlrev_b32 v44, 1, v42
    v_xor_b32 v44, v43, v44
    v_xor_b32 v45, 8, v44
    v_lshlrev_b32 v44, 4, v44
    v_lshlrev_b32 v45, 4, v45
    v_lshl_add_u32 v6, v42, 13, v44
    v_lshl_add_u32 v8, v42, 13, v45
    v_add_u32 v7, 31744, v6
    v_add_u32 v9, 95232, v8
    v_add_u32 v8, 63488, v8
    v_mul_u32_u24 v46, 896, v42
    v_add_u32 v14, v46, v44
    v_add_u32 v16, v46, v45
    v_add_u32 v15, 2560, v14
    v_add_u32 v17, 7680, v16
    v_add_u32 v16, 5120, v16
    s_cmp_eq_u32 s70, 3
    s_cselect_b32 s73, 128, -1
    v_mov_b32 v47, 0x80000000
    v_cmp_le_u32 vcc, s73, v44
    s_nop 1
    v_cndmask_b32 v14, v14, v47, vcc
    v_cndmask_b32 v15, v15, v47, vcc
    v_cmp_le_u32 vcc, s73, v45
    s_nop 1
    v_cndmask_b32 v16, v16, v47, vcc
    v_cndmask_b32 v17, v17, v47, vcc
    v_lshrrev_b32 v42, 3, v1
    v_and_b32 v43, 7, v1
    v_lshrrev_b32 v44, 1, v42
    v_xor_b32 v44, v43, v44
    v_xor_b32 v45, 4, v44
    v_lshlrev_b32 v44, 4, v44
    v_lshlrev_b32 v45, 4, v45
    v_mul_u32_u24 v46, 896, v42
    v_add_u32 v2, v46, v44
    v_add_u32 v3, v46, v45
    v_add_u32 v4, 12288, v2
    v_add_u32 v5, 18432, v3
    v_add_u32 v3, 6144, v3
    v_lshl_add_u32 v10, v42, 9, v44
    v_lshl_add_u32 v11, v42, 9, v45
    v_add_u32 v12, 6144, v10
    v_add_u32 v13, 9216, v11
    v_add_u32 v11, 3072, v11
    s_lshl_b32 s83, s68, 12
    s_and_b32 s73, s68, 1
    s_lshr_b32 s74, s68, 1
    s_lshl_b32 s75, s73, 13
    s_lshl_b32 s76, s74, 12
    s_add_u32 s81, s75, s76
    s_add_u32 s82, s83, 65536
    s_lshl_b32 s35, s68, 14
    s_add_u32 s35, s35, 98304
    s_lshr_b32 s75, s69, 1
    s_mov_b32 s77, 0x2024040
    s_cmp_eq_u32 s75, 1
    s_cselect_b32 s77, 0x5054444, s77
    s_cmp_eq_u32 s75, 2
    s_cselect_b32 s77, 0x2024040, s77
    s_cmp_eq_u32 s75, 3
    s_cselect_b32 s77, 0x5054444, s77
    s_bfe_u32 s75, s2, 0x30003
    s_lshl_b32 s75, s75, 2
    s_lshr_b32 s77, s77, s75
    s_and_b32 s77, s77, 15
    s_lshl_b32 s78, s77, 19
    s_lshl_b32 s79, s77, 7
    s_lshl_b32 s96, s69, 2
    s_add_u32 s96, s96, s68
    s_mul_i32 s96, s96, 28672
    s_lshl_b32 s94, s71, 2
    s_add_u32 s94, s94, s70
    s_lshl_b32 s97, s94, 1
    s_add_u32 s97, s97, s73
    s_lshl_b32 s97, s97, 8
    s_lshl_b32 s74, s74, 17
    s_add_u32 s97, s97, s74
    s_sub_u32 s38, 917504, s96
    s_mov_b32 s39, 0x20000
    s_sub_u32 s42, 3670016, s97
    s_mov_b32 s43, 0x20000
    s_mov_b32 m0, s82
    s_cmp_eq_u32 s72, 0
    s_waitcnt lgkmcnt(0)
    s_cselect_b64 s[36:37], s[8:9], s[18:19]
    s_cselect_b64 s[40:41], s[14:15], s[24:25]
    s_cselect_b64 s[44:45], s[10:11], s[20:21]
    s_cselect_b64 s[52:53], s[22:23], s[12:13]
    s_cselect_b64 s[48:49], s[26:27], s[16:17]
    s_cselect_b32 s80, 17, 18
    s_add_u32 s36, s36, s96
    s_addc_u32 s37, s37, 0
    buffer_load_dwordx4 v2, s[36:39], s79 offen offset:0  lds
    buffer_load_dwordx4 v3, s[36:39], s79 offen offset:1024  lds
    buffer_load_dwordx4 v4, s[36:39], s79 offen offset:2048  lds
    buffer_load_dwordx4 v5, s[36:39], s79 offen offset:3072  lds
    s_add_u32 s79, s79, 128
    s_cmp_eq_u32 s79, 896
    s_cselect_b32 s79, 0, s79
    s_add_u32 s40, s40, s97
    s_addc_u32 s41, s41, 0
    s_add_u32 m0, s81, 0
    s_nop 0
    buffer_load_dwordx4 v6, s[40:43], s78 offen offset:0  lds
    buffer_load_dwordx4 v7, s[40:43], s78 offen offset:1024  lds
    buffer_load_dwordx4 v8, s[40:43], s78 offen offset:2048  lds
    buffer_load_dwordx4 v9, s[40:43], s78 offen offset:3072  lds
    s_add_u32 s78, s78, 262144
    s_cmp_eq_u32 s78, 3670016
    s_cselect_b32 s78, 0, s78
    s_add_u32 m0, s81, 16384
    s_nop 0
    buffer_load_dwordx4 v6, s[40:43], s78 offen offset:0  lds
    buffer_load_dwordx4 v7, s[40:43], s78 offen offset:1024  lds
    buffer_load_dwordx4 v8, s[40:43], s78 offen offset:2048  lds
    buffer_load_dwordx4 v9, s[40:43], s78 offen offset:3072  lds
    s_add_u32 s78, s78, 262144
    s_cmp_eq_u32 s78, 3670016
    s_cselect_b32 s78, 0, s78
    s_getpc_b64 s[2:3]
L_pc:
    s_lshl_b32 s74, s69, 2
    s_add_u32 s74, s74, s70
    s_lshl_b32 s74, s74, 7
    v_lshl_add_u32 v42, v1, 12, s74
    v_min_u32 v42, L_end-L_pc-4, v42
    s_cmp_lg_u32 s68, 3
    s_cbranch_scc1 L_nopf
    s_mov_b64 exec, 0xff
    global_load_dword v0, v42, s[2:3]
    s_mov_b64 exec, -1
L_nopf:
    s_xor_b32 s74, s72, 1
    s_lshr_b32 s75, s94, s74
    s_lshl_b32 s75, s75, 14
    s_lshl_b32 s76, s69, 2
    s_lshl_b32 s76, s76, s80
    s_add_u32 s75, s75, s76
    s_lshl_b32 s76, s68, 7
    s_add_u32 s75, s75, s76
    s_lshl_b32 s76, 32, s80
    s_add_u32 s44, s44, s75
    s_addc_u32 s45, s45, 0
    s_sub_u32 s46, s76, s75
    s_mov_b32 s47, 0x20000
    s_lshl_b32 s80, 1, s80
    v_lshrrev_b32 v42, 4, v1
    v_bfe_u32 v43, v1, 2, 2
    v_and_b32 v44, 3, v1
    v_and_b32 v45, 1, v42
    v_lshl_add_u32 v46, v45, 2, v43
    v_lshlrev_b32 v46, 5, v46
    v_lshl_add_u32 v46, v44, 3, v46
    v_lshl_add_u32 v45, v45, 3, v43
    v_lshl_add_u32 v46, v45, 8, v46
    v_lshrrev_b32 v45, 1, v42
    s_and_b32 s73, s68, 1
    s_lshl_b32 s73, s73, 13
    v_lshl_add_u32 v18, v45, 12, v46
    v_add_u32 v18, s73, v18
    v_lshl_add_u32 v26, v45, 14, v46
    v_add_u32 v26, s83, v26
    v_xor_b32 v19, 32, v18
    v_xor_b32 v27, 32, v26
    v_xor_b32 v20, 64, v18
    v_xor_b32 v28, 64, v26
    v_xor_b32 v21, 96, v18
    v_xor_b32 v29, 96, v26
    v_xor_b32 v22, 128, v18
    v_xor_b32 v30, 128, v26
    v_xor_b32 v23, 160, v18
    v_xor_b32 v31, 160, v26
    v_xor_b32 v24, 192, v18
    v_xor_b32 v32, 192, v26
    v_xor_b32 v25, 224, v18
    v_xor_b32 v33, 224, v26
    v_and_b32 v43, 15, v1
    v_lshrrev_b32 v44, 1, v43
    v_xor_b32 v46, v42, v44
    v_lshlrev_b32 v46, 4, v46
    v_lshl_add_u32 v46, v43, 7, v46
    s_xor_b32 s75, s82, 4096
    v_add_u32 v36, s82, v46
    v_add_u32 v34, s75, v46
    v_add_u32 v38, s83, v46
    v_xor_b32 v37, 64, v36
    v_xor_b32 v35, 64, v34
    v_xor_b32 v39, 64, v38
    v_lshlrev_b32 v40, 4, v1
    v_xor_b32 v44, v45, v44
    v_lshlrev_b32 v44, 4, v44
    v_lshl_add_u32 v44, v43, 7, v44
    v_and_b32 v42, 1, v42
    v_lshl_add_u32 v44, v42, 3, v44
    s_add_u32 s73, s73, s35
    s_lshl_b32 s74, s68, 14
    s_xor_b32 s75, s74, 16384
    s_sub_u32 s75, s75, s74
    s_add_u32 s77, s75, s73
    v_add_u32 v120, s77, v44
    v_add_u32 v124, s73, v44
    v_xor_b32 v121, 32, v120
    v_xor_b32 v125, 32, v124
    v_xor_b32 v122, 64, v120
    v_xor_b32 v126, 64, v124
    v_xor_b32 v123, 96, v120
    v_xor_b32 v127, 96, v124
    s_mov_b64 s[56:57], s[32:33]
    s_mov_b32 s58, 268435456
    s_mov_b32 s59, 0x20000
    s_mov_b64 s[64:65], s[30:31]
    s_mov_b32 s66, 256
    s_mov_b32 s67, 0x20000
    s_mov_b64 s[60:61], s[28:29]
    s_or_b32 s94, s71, s72
    s_or_b32 s94, s94, s70
    s_or_b32 s94, s94, s68
    s_lshl_b32 s73, s69, 7
    s_cmp_lg_u32 s94, 0
    s_cbranch_scc1 L_nolead0
    buffer_load_dword v46, off, s[56:59], s73 sc1
L_nolead0:
    s_add_u32 m0, s82, 16384
    s_nop 0
    buffer_load_dwordx4 v2, s[36:39], s79 offen offset:0  lds
    buffer_load_dwordx4 v3, s[36:39], s79 offen offset:1024  lds
    buffer_load_dwordx4 v4, s[36:39], s79 offen offset:2048  lds
    buffer_load_dwordx4 v5, s[36:39], s79 offen offset:3072  lds
    s_add_u32 s79, s79, 128
    s_cmp_eq_u32 s79, 896
    s_cselect_b32 s79, 0, s79
    s_add_u32 m0, s81, 32768
    s_nop 0
    buffer_load_dwordx4 v6, s[40:43], s78 offen offset:0  lds
    buffer_load_dwordx4 v7, s[40:43], s78 offen offset:1024  lds
    buffer_load_dwordx4 v8, s[40:43], s78 offen offset:2048  lds
    buffer_load_dwordx4 v9, s[40:43], s78 offen offset:3072  lds
    s_add_u32 s78, s78, 262144
    s_cmp_eq_u32 s78, 3670016
    s_cselect_b32 s78, 0, s78
    s_branch L_body
.p2align 12
L_body:
    s_waitcnt vmcnt(12)
    s_barrier
    ds_read_b128 v[88:91], v34 offset:0
    ds_read_b128 v[92:95], v34 offset:2048
    ds_read_b128 v[96:99], v36 offset:0
    ds_read_b128 v[100:103], v36 offset:2048
    ds_read_b64_tr_b16 v[48:49], v18 offset:0
    ds_read_b64_tr_b16 v[50:51], v18 offset:1024
    ds_read_b64_tr_b16 v[52:53], v19 offset:0
    ds_read_b64_tr_b16 v[54:55], v19 offset:1024
    ds_read_b64_tr_b16 v[56:57], v20 offset:0
    ds_read_b64_tr_b16 v[58:59], v20 offset:1024
    ds_read_b64_tr_b16 v[60:61], v21 offset:0
    ds_read_b64_tr_b16 v[62:63], v21 offset:1024
    s_add_u32 m0, s81, 49152
    s_nop 0
    buffer_load_dwordx4 v6, s[40:43], s78 offen offset:0  lds
    buffer_load_dwordx4 v7, s[40:43], s78 offen offset:1024  lds
    buffer_load_dwordx4 v8, s[40:43], s78 offen offset:2048  lds
    buffer_load_dwordx4 v9, s[40:43], s78 offen offset:3072  lds
    s_add_u32 s78, s78, 262144
    s_cmp_eq_u32 s78, 3670016
    s_cselect_b32 s78, 0, s78
    ds_read_b64_tr_b16 v[64:65], v22 offset:0
    ds_read_b64_tr_b16 v[66:67], v22 offset:1024
    ds_read_b64_tr_b16 v[68:69], v23 offset:0
    ds_read_b64_tr_b16 v[70:71], v23 offset:1024
    ds_read_b64_tr_b16 v[72:73], v24 offset:0
    ds_read_b64_tr_b16 v[74:75], v24 offset:1024
    ds_read_b64_tr_b16 v[76:77], v25 offset:0
    ds_read_b64_tr_b16 v[78:79], v25 offset:1024
    s_waitcnt vmcnt(12) lgkmcnt(0)
    s_barrier
    v_mfma_f32_16x16x32_bf16 v[128:131], v[48:51], v[88:91], 0
    s_add_u32 m0, s81, 0
    ds_read_b64_tr_b16 v[80:81], v18 offset:16384
    v_mfma_f32_16x16x32_bf16 v[132:135], v[48:51], v[92:95], 0
    buffer_load_dwordx4 v6, s[40:43], s78 offen offset:0  lds
    ds_read_b64_tr_b16 v[82:83], v18 offset:17408
    v_mfma_f32_16x16x32_bf16 v[136:139], v[48:51], v[96:99], 0
    ds_read_b64_tr_b16 v[84:85], v19 offset:16384
    ds_read_b64_tr_b16 v[86:87], v19 offset:17408
    v_mfma_f32_16x16x32_bf16 v[140:143], v[48:51], v[100:103], 0
    s_lshl_b32 s75, s71, 2
    ds_read_b64_tr_b16 v[48:49], v20 offset:16384
    v_mfma_f32_16x16x32_bf16 v[144:147], v[52:55], v[88:91], 0
    s_add_u32 s75, s75, s68
    ds_read_b64_tr_b16 v[50:51], v20 offset:17408
    v_mfma_f32_16x16x32_bf16 v[148:151], v[52:55], v[92:95], 0
    buffer_load_dwordx4 v7, s[40:43], s78 offen offset:1024  lds
    s_mul_i32 s73, s75, 229376
    v_mfma_f32_16x16x32_bf16 v[152:155], v[52:55], v[96:99], 0
    s_lshl_b32 s74, s70, 8
    s_add_u32 s73, s73, s74
    v_mfma_f32_16x16x32_bf16 v[156:159], v[52:55], v[100:103], 0
    ds_read_b64_tr_b16 v[52:53], v21 offset:16384
    ds_read_b64_tr_b16 v[54:55], v21 offset:17408
    v_mfma_f32_16x16x32_bf16 v[160:163], v[56:59], v[88:91], 0
    s_add_u32 s48, s48, s73
    s_addc_u32 s49, s49, 0
    v_mfma_f32_16x16x32_bf16 v[164:167], v[56:59], v[92:95], 0
    buffer_load_dwordx4 v8, s[40:43], s78 offen offset:2048  lds
    s_sub_u32 s50, 3670016, s73
    v_mfma_f32_16x16x32_bf16 v[168:171], v[56:59], v[96:99], 0
    s_mov_b32 s51, 0x20000
    s_lshr_b32 s75, s75, s72
    v_mfma_f32_16x16x32_bf16 v[172:175], v[56:59], v[100:103], 0
    ds_read_b64_tr_b16 v[56:57], v22 offset:16384
    ds_read_b64_tr_b16 v[58:59], v22 offset:17408
    v_mfma_f32_16x16x32_bf16 v[176:179], v[60:63], v[88:91], 0
    ds_read_b128 v[104:107], v35 offset:0
    s_lshl_b32 s75, s75, 14
    v_mfma_f32_16x16x32_bf16 v[180:183], v[60:63], v[92:95], 0
    buffer_load_dwordx4 v9, s[40:43], s78 offen offset:3072  lds
    ds_read_b128 v[108:111], v35 offset:2048
    v_mfma_f32_16x16x32_bf16 v[184:187], v[60:63], v[96:99], 0
    s_add_u32 s78, s78, 262144
    s_cmp_eq_u32 s78, 3670016
    s_cselect_b32 s78, 0, s78
    v_mfma_f32_16x16x32_bf16 v[188:191], v[60:63], v[100:103], 0
    s_add_u32 m0, s83, 98304
    s_mul_i32 s34, s80, 0
    v_mfma_f32_16x16x32_bf16 v[192:195], v[64:67], v[88:91], 0
    ds_read_b64_tr_b16 v[60:61], v23 offset:16384
    ds_read_b64_tr_b16 v[62:63], v23 offset:17408
    v_mfma_f32_16x16x32_bf16 v[196:199], v[64:67], v[92:95], 0
    buffer_load_dwordx4 v10, s[44:47], s34 offen offset:0  lds
    s_sub_u32 s74, 18, s72
    v_mfma_f32_16x16x32_bf16 v[200:203], v[64:67], v[96:99], 0
    ds_read_b128 v[112:115], v37 offset:0
    s_lshl_b32 s76, s69, 2
    v_mfma_f32_16x16x32_bf16 v[204:207], v[64:67], v[100:103], 0
    ds_read_b64_tr_b16 v[64:65], v24 offset:16384
    ds_read_b64_tr_b16 v[66:67], v24 offset:17408
    v_mfma_f32_16x16x32_bf16 v[208:211], v[68:71], v[88:91], 0
    ds_read_b128 v[116:119], v37 offset:2048
    s_lshl_b32 s76, s76, s74
    v_mfma_f32_16x16x32_bf16 v[212:215], v[68:71], v[92:95], 0
    buffer_load_dwordx4 v11, s[44:47], s34 offen offset:1024  lds
    s_add_u32 s75, s75, s76
    v_mfma_f32_16x16x32_bf16 v[216:219], v[68:71], v[96:99], 0
    s_lshl_b32 s76, 32, s74
    v_mfma_f32_16x16x32_bf16 v[220:223], v[68:71], v[100:103], 0
    ds_read_b64_tr_b16 v[68:69], v25 offset:16384
    ds_read_b64_tr_b16 v[70:71], v25 offset:17408
    v_mfma_f32_16x16x32_bf16 v[224:227], v[72:75], v[88:91], 0
    s_add_u32 s52, s52, s75
    s_addc_u32 s53, s53, 0
    v_mfma_f32_16x16x32_bf16 v[228:231], v[72:75], v[92:95], 0
    s_sub_u32 s54, s76, s75
    s_mov_b32 s55, 0x20000
    v_mfma_f32_16x16x32_bf16 v[232:235], v[72:75], v[96:99], 0
    s_xor_b32 s75, s72, 1
    s_lshl_b32 s75, s75, 3
    v_mfma_f32_16x16x32_bf16 v[236:239], v[72:75], v[100:103], 0
    s_add_u32 s75, s75, s69
    s_lshl_b32 s75, s75, 4
    v_mfma_f32_16x16x32_bf16 v[240:243], v[76:79], v[88:91], 0
    s_add_u32 s75, s75, s70
    v_mfma_f32_16x16x32_bf16 v[244:247], v[76:79], v[92:95], 0
    v_mfma_f32_16x16x32_bf16 v[248:251], v[76:79], v[96:99], 0
    v_mfma_f32_16x16x32_bf16 v[252:255], v[76:79], v[100:103], 0
    s_waitcnt vmcnt(10) lgkmcnt(0)
    s_barrier
    v_mfma_f32_16x16x32_bf16 v[128:131], v[80:83], v[104:107], v[128:131]
    s_add_u32 m0, s82, 0
    ds_read_b64_tr_b16 v[72:73], v18 offset:32768
    v_mfma_f32_16x16x32_bf16 v[132:135], v[80:83], v[108:111], v[132:135]
    buffer_load_dwordx4 v2, s[36:39], s79 offen offset:0  lds
    ds_read_b64_tr_b16 v[74:75], v18 offset:33792
    v_mfma_f32_16x16x32_bf16 v[136:139], v[80:83], v[112:115], v[136:139]
    ds_read_b64_tr_b16 v[76:77], v19 offset:32768
    ds_read_b64_tr_b16 v[78:79], v19 offset:33792
    v_mfma_f32_16x16x32_bf16 v[140:143], v[80:83], v[116:119], v[140:143]
    s_add_u32 s73, s71, 1
    ds_read_b64_tr_b16 v[80:81], v20 offset:32768
    v_mfma_f32_16x16x32_bf16 v[144:147], v[84:87], v[104:107], v[144:147]
    s_and_b32 s73, s73, 3
    ds_read_b64_tr_b16 v[82:83], v20 offset:33792
    v_mfma_f32_16x16x32_bf16 v[148:151], v[84:87], v[108:111], v[148:151]
    buffer_load_dwordx4 v3, s[36:39], s79 offen offset:1024  lds
    s_lshl_b32 s88, s73, s74
    v_mfma_f32_16x16x32_bf16 v[152:155], v[84:87], v[112:115], v[152:155]
    s_lshl_b32 s73, s73, 2
    s_add_u32 s98, s75, s73
    v_mfma_f32_16x16x32_bf16 v[156:159], v[84:87], v[116:119], v[156:159]
    ds_read_b64_tr_b16 v[84:85], v21 offset:32768
    ds_read_b64_tr_b16 v[86:87], v21 offset:33792
    v_mfma_f32_16x16x32_bf16 v[160:163], v[48:51], v[104:107], v[160:163]
    s_add_u32 s73, s71, 2
    s_and_b32 s73, s73, 3
    v_mfma_f32_16x16x32_bf16 v[164:167], v[48:51], v[108:111], v[164:167]
    buffer_load_dwordx4 v4, s[36:39], s79 offen offset:2048  lds
    s_lshl_b32 s89, s73, s74
    v_mfma_f32_16x16x32_bf16 v[168:171], v[48:51], v[112:115], v[168:171]
    s_lshl_b32 s73, s73, 2
    ds_read_b128 v[88:91], v34 offset:16384
    v_mfma_f32_16x16x32_bf16 v[172:175], v[48:51], v[116:119], v[172:175]
    ds_read_b64_tr_b16 v[48:49], v22 offset:32768
    ds_read_b64_tr_b16 v[50:51], v22 offset:33792
    v_mfma_f32_16x16x32_bf16 v[176:179], v[52:55], v[104:107], v[176:179]
    s_add_u32 s99, s75, s73
    ds_read_b128 v[92:95], v34 offset:18432
    v_mfma_f32_16x16x32_bf16 v[180:183], v[52:55], v[108:111], v[180:183]
    buffer_load_dwordx4 v5, s[36:39], s79 offen offset:3072  lds
    s_add_u32 s73, s71, 3
    v_mfma_f32_16x16x32_bf16 v[184:187], v[52:55], v[112:115], v[184:187]
    s_add_u32 s79, s79, 128
    s_cmp_eq_u32 s79, 896
    s_cselect_b32 s79, 0, s79
    v_mfma_f32_16x16x32_bf16 v[188:191], v[52:55], v[116:119], v[188:191]
    s_add_u32 m0, s81, 16384
    ds_read_b64_tr_b16 v[52:53], v23 offset:32768
    v_mfma_f32_16x16x32_bf16 v[192:195], v[56:59], v[104:107], v[192:195]
    ds_read_b64_tr_b16 v[54:55], v23 offset:33792
    ds_read_b128 v[96:99], v36 offset:16384
    v_mfma_f32_16x16x32_bf16 v[196:199], v[56:59], v[108:111], v[196:199]
    buffer_load_dwordx4 v6, s[40:43], s78 offen offset:0  lds
    s_and_b32 s73, s73, 3
    v_mfma_f32_16x16x32_bf16 v[200:203], v[56:59], v[112:115], v[200:203]
    ds_read_b128 v[100:103], v36 offset:18432
    s_lshl_b32 s90, s73, s74
    v_mfma_f32_16x16x32_bf16 v[204:207], v[56:59], v[116:119], v[204:207]
    ds_read_b64_tr_b16 v[56:57], v24 offset:32768
    ds_read_b64_tr_b16 v[58:59], v24 offset:33792
    v_mfma_f32_16x16x32_bf16 v[208:211], v[60:63], v[104:107], v[208:211]
    s_lshl_b32 s73, s73, 2
    s_add_u32 s100, s75, s73
    v_mfma_f32_16x16x32_bf16 v[212:215], v[60:63], v[108:111], v[212:215]
    buffer_load_dwordx4 v7, s[40:43], s78 offen offset:1024  lds
    s_add_u32 s73, s71, 4
    v_mfma_f32_16x16x32_bf16 v[216:219], v[60:63], v[112:115], v[216:219]
    s_add_u32 m0, s83, 114688
    s_mul_i32 s34, s80, 1
    v_mfma_f32_16x16x32_bf16 v[220:223], v[60:63], v[116:119], v[220:223]
    ds_read_b64_tr_b16 v[60:61], v25 offset:32768
    ds_read_b64_tr_b16 v[62:63], v25 offset:33792
    v_mfma_f32_16x16x32_bf16 v[224:227], v[64:67], v[104:107], v[224:227]
    s_and_b32 s73, s73, 3
    s_lshl_b32 s91, s73, s74
    v_mfma_f32_16x16x32_bf16 v[228:231], v[64:67], v[108:111], v[228:231]
    buffer_load_dwordx4 v10, s[44:47], s34 offen offset:0  lds
    s_lshl_b32 s73, s73, 2
    v_mfma_f32_16x16x32_bf16 v[232:235], v[64:67], v[112:115], v[232:235]
    s_add_u32 s101, s75, s73
    s_add_u32 s92, s70, s69
    v_mfma_f32_16x16x32_bf16 v[236:239], v[64:67], v[116:119], v[236:239]
    s_and_b32 s92, s92, 3
    s_add_u32 s73, s92, 0
    v_mfma_f32_16x16x32_bf16 v[240:243], v[68:71], v[104:107], v[240:243]
    v_mfma_f32_16x16x32_bf16 v[244:247], v[68:71], v[108:111], v[244:247]
    buffer_load_dwordx4 v11, s[44:47], s34 offen offset:1024  lds
    v_mfma_f32_16x16x32_bf16 v[248:251], v[68:71], v[112:115], v[248:251]
    v_mfma_f32_16x16x32_bf16 v[252:255], v[68:71], v[116:119], v[252:255]
    s_mov_b64 exec, 0
    s_cmp_eq_u32 s68, 1
    s_cbranch_scc1 L_pad1
    s_cmp_eq_u32 s68, 2
    s_cbranch_scc1 L_pad2
    s_cmp_eq_u32 s68, 3
    s_cbranch_scc1 L_pad3
    s_branch L_pad0
L_warm0:
    s_mov_b64 exec, -1
    s_waitcnt vmcnt(14) lgkmcnt(0)
    s_barrier
    v_mfma_f32_16x16x32_bf16 v[128:131], v[72:75], v[88:91], v[128:131]
    s_add_u32 m0, s81, 16384
    ds_read_b64_tr_b16 v[64:65], v18 offset:49152
    v_mfma_f32_16x16x32_bf16 v[132:135], v[72:75], v[92:95], v[132:135]
    buffer_load_dwordx4 v8, s[40:43], s78 offen offset:2048  lds
    ds_read_b64_tr_b16 v[66:67], v18 offset:50176
    v_mfma_f32_16x16x32_bf16 v[136:139], v[72:75], v[96:99], v[136:139]
    ds_read_b64_tr_b16 v[68:69], v19 offset:49152
    ds_read_b64_tr_b16 v[70:71], v19 offset:50176
    v_mfma_f32_16x16x32_bf16 v[140:143], v[72:75], v[100:103], v[140:143]
    s_and_b32 s73, s73, 3
    ds_read_b64_tr_b16 v[72:73], v20 offset:49152
    v_mfma_f32_16x16x32_bf16 v[144:147], v[76:79], v[88:91], v[144:147]
    s_lshl_b32 s84, s73, 7
    ds_read_b64_tr_b16 v[74:75], v20 offset:50176
    v_mfma_f32_16x16x32_bf16 v[148:151], v[76:79], v[92:95], v[148:151]
    buffer_load_dwordx4 v9, s[40:43], s78 offen offset:3072  lds
    s_add_u32 s73, s92, 1
    v_mfma_f32_16x16x32_bf16 v[152:155], v[76:79], v[96:99], v[152:155]
    s_add_u32 s78, s78, 262144
    s_cmp_eq_u32 s78, 3670016
    s_cselect_b32 s78, 0, s78
    v_mfma_f32_16x16x32_bf16 v[156:159], v[76:79], v[100:103], v[156:159]
    s_add_u32 m0, s81, 32768
    ds_read_b64_tr_b16 v[76:77], v21 offset:49152
    v_mfma_f32_16x16x32_bf16 v[160:163], v[80:83], v[88:91], v[160:163]
    s_and_b32 s73, s73, 3
    ds_read_b64_tr_b16 v[78:79], v21 offset:50176
    v_mfma_f32_16x16x32_bf16 v[164:167], v[80:83], v[92:95], v[164:167]
    buffer_load_dwordx4 v6, s[40:43], s78 offen offset:0  lds
    s_lshl_b32 s85, s73, 7
    v_mfma_f32_16x16x32_bf16 v[168:171], v[80:83], v[96:99], v[168:171]
    s_add_u32 s73, s92, 2
    s_and_b32 s73, s73, 3
    v_mfma_f32_16x16x32_bf16 v[172:175], v[80:83], v[100:103], v[172:175]
    ds_read_b64_tr_b16 v[80:81], v22 offset:49152
    ds_read_b64_tr_b16 v[82:83], v22 offset:50176
    v_mfma_f32_16x16x32_bf16 v[176:179], v[84:87], v[88:91], v[176:179]
    s_lshl_b32 s86, s73, 7
    s_add_u32 s73, s92, 3
    v_mfma_f32_16x16x32_bf16 v[180:183], v[84:87], v[92:95], v[180:183]
    buffer_load_dwordx4 v7, s[40:43], s78 offen offset:1024  lds
    ds_read_b128 v[104:107], v35 offset:16384
    v_mfma_f32_16x16x32_bf16 v[184:187], v[84:87], v[96:99], v[184:187]
    s_and_b32 s73, s73, 3
    ds_read_b128 v[108:111], v35 offset:18432
    v_mfma_f32_16x16x32_bf16 v[188:191], v[84:87], v[100:103], v[188:191]
    ds_read_b64_tr_b16 v[84:85], v23 offset:49152
    ds_read_b64_tr_b16 v[86:87], v23 offset:50176
    v_mfma_f32_16x16x32_bf16 v[192:195], v[48:51], v[88:91], v[192:195]
    s_lshl_b32 s87, s73, 7
    ds_read_b128 v[112:115], v37 offset:16384
    v_mfma_f32_16x16x32_bf16 v[196:199], v[48:51], v[92:95], v[196:199]
    buffer_load_dwordx4 v8, s[40:43], s78 offen offset:2048  lds
    s_mul_i32 s92, s92, 57344
    v_mfma_f32_16x16x32_bf16 v[200:203], v[48:51], v[96:99], v[200:203]
    ds_read_b128 v[116:119], v37 offset:18432
    s_lshl_b32 s73, s69, 2
    v_mfma_f32_16x16x32_bf16 v[204:207], v[48:51], v[100:103], v[204:207]
    ds_read_b64_tr_b16 v[48:49], v24 offset:49152
    ds_read_b64_tr_b16 v[50:51], v24 offset:50176
    v_mfma_f32_16x16x32_bf16 v[208:211], v[52:55], v[88:91], v[208:211]
    s_add_u32 s73, s73, s71
    s_mul_i32 s73, s73, 57344
    v_mfma_f32_16x16x32_bf16 v[212:215], v[52:55], v[92:95], v[212:215]
    buffer_load_dwordx4 v9, s[40:43], s78 offen offset:3072  lds
    s_xor_b32 s74, s72, 1
    v_mfma_f32_16x16x32_bf16 v[216:219], v[52:55], v[96:99], v[216:219]
    s_add_u32 s78, s78, 262144
    s_cmp_eq_u32 s78, 3670016
    s_cselect_b32 s78, 0, s78
    v_mfma_f32_16x16x32_bf16 v[220:223], v[52:55], v[100:103], v[220:223]
    s_add_u32 m0, s83, 131072
    s_mul_i32 s34, s80, 2
    v_mfma_f32_16x16x32_bf16 v[224:227], v[56:59], v[88:91], v[224:227]
    ds_read_b64_tr_b16 v[52:53], v25 offset:49152
    ds_read_b64_tr_b16 v[54:55], v25 offset:50176
    v_mfma_f32_16x16x32_bf16 v[228:231], v[56:59], v[92:95], v[228:231]
    buffer_load_dwordx4 v10, s[44:47], s34 offen offset:0  lds
    s_mul_i32 s74, s74, 896
    v_mfma_f32_16x16x32_bf16 v[232:235], v[56:59], v[96:99], v[232:235]
    s_add_u32 s73, s73, s74
    s_lshl_b32 s74, s70, 8
    v_mfma_f32_16x16x32_bf16 v[236:239], v[56:59], v[100:103], v[236:239]
    s_add_u32 s73, s73, s74
    s_lshl_b32 s74, s68, 6
    v_mfma_f32_16x16x32_bf16 v[240:243], v[60:63], v[88:91], v[240:243]
    s_add_u32 s73, s73, s74
    v_mfma_f32_16x16x32_bf16 v[244:247], v[60:63], v[92:95], v[244:247]
    buffer_load_dwordx4 v11, s[44:47], s34 offen offset:1024  lds
    v_mfma_f32_16x16x32_bf16 v[248:251], v[60:63], v[96:99], v[248:251]
    s_add_u32 s60, s60, s73
    s_addc_u32 s61, s61, 0
    v_mfma_f32_16x16x32_bf16 v[252:255], v[60:63], v[100:103], v[252:255]
    s_mov_b64 exec, 0
    s_cmp_eq_u32 s68, 1
    s_cbranch_scc1 L_warm1
    s_cmp_eq_u32 s68, 2
    s_cbranch_scc1 L_warm1
    s_cmp_eq_u32 s68, 3
    s_cbranch_scc1 L_warm1
    s_branch L_pad4
L_warm1:
    s_mov_b64 exec, -1
    s_waitcnt vmcnt(12) lgkmcnt(0)
    s_barrier
    v_mfma_f32_16x16x32_bf16 v[128:131], v[64:67], v[104:107], v[128:131]
    s_add_u32 m0, s82, 16384
    ds_read_b64_tr_b16 v[56:57], v18 offset:0
    v_mfma_f32_16x16x32_bf16 v[132:135], v[64:67], v[108:111], v[132:135]
    buffer_load_dwordx4 v2, s[36:39], s79 offen offset:0  lds
    ds_read_b64_tr_b16 v[58:59], v18 offset:1024
    v_mfma_f32_16x16x32_bf16 v[136:139], v[64:67], v[112:115], v[136:139]
    ds_read_b64_tr_b16 v[60:61], v19 offset:0
    ds_read_b64_tr_b16 v[62:63], v19 offset:1024
    v_mfma_f32_16x16x32_bf16 v[140:143], v[64:67], v[116:119], v[140:143]
    ds_read_b64_tr_b16 v[64:65], v20 offset:0
    s_sub_u32 s62, 1835008, s73
    v_mfma_f32_16x16x32_bf16 v[144:147], v[68:71], v[104:107], v[144:147]
    ds_read_b64_tr_b16 v[66:67], v20 offset:1024
    s_mov_b32 s63, 0x20000
    v_mfma_f32_16x16x32_bf16 v[148:151], v[68:71], v[108:111], v[148:151]
    buffer_load_dwordx4 v3, s[36:39], s79 offen offset:1024  lds
    s_lshl_b32 s73, s72, 3
    v_mfma_f32_16x16x32_bf16 v[152:155], v[68:71], v[112:115], v[152:155]
    s_add_u32 s73, s73, s69
    s_lshl_b32 s73, s73, 2
    v_mfma_f32_16x16x32_bf16 v[156:159], v[68:71], v[116:119], v[156:159]
    ds_read_b64_tr_b16 v[68:69], v21 offset:0
    ds_read_b64_tr_b16 v[70:71], v21 offset:1024
    v_mfma_f32_16x16x32_bf16 v[160:163], v[72:75], v[104:107], v[160:163]
    s_add_u32 s73, s73, s71
    s_lshl_b32 s96, s73, 16
    v_mfma_f32_16x16x32_bf16 v[164:167], v[72:75], v[108:111], v[164:167]
    buffer_load_dwordx4 v4, s[36:39], s79 offen offset:2048  lds
    s_lshl_b32 s74, s68, 14
    v_mfma_f32_16x16x32_bf16 v[168:171], v[72:75], v[112:115], v[168:171]
    ds_read_b128 v[88:91], v34 offset:0
    s_add_u32 s96, s96, s74
    v_mfma_f32_16x16x32_bf16 v[172:175], v[72:75], v[116:119], v[172:175]
    ds_read_b64_tr_b16 v[72:73], v22 offset:0
    ds_read_b64_tr_b16 v[74:75], v22 offset:1024
    v_mfma_f32_16x16x32_bf16 v[176:179], v[76:79], v[104:107], v[176:179]
    ds_read_b128 v[92:95], v34 offset:2048
    s_xor_b32 s74, s70, 0
    v_mfma_f32_16x16x32_bf16 v[180:183], v[76:79], v[108:111], v[180:183]
    buffer_load_dwordx4 v5, s[36:39], s79 offen offset:3072  lds
    ds_read_b128 v[96:99], v36 offset:0
    v_mfma_f32_16x16x32_bf16 v[184:187], v[76:79], v[112:115], v[184:187]
    s_add_u32 s79, s79, 128
    s_cmp_eq_u32 s79, 896
    s_cselect_b32 s79, 0, s79
    v_mfma_f32_16x16x32_bf16 v[188:191], v[76:79], v[116:119], v[188:191]
    s_add_u32 m0, s81, 49152
    ds_read_b64_tr_b16 v[76:77], v23 offset:0
    v_mfma_f32_16x16x32_bf16 v[192:195], v[80:83], v[104:107], v[192:195]
    ds_read_b64_tr_b16 v[78:79], v23 offset:1024
    s_lshl_b32 s74, s74, 12
    v_mfma_f32_16x16x32_bf16 v[196:199], v[80:83], v[108:111], v[196:199]
    buffer_load_dwordx4 v6, s[40:43], s78 offen offset:0  lds
    ds_read_b128 v[100:103], v36 offset:2048
    v_mfma_f32_16x16x32_bf16 v[200:203], v[80:83], v[112:115], v[200:203]
    s_add_u32 s96, s96, s74
    s_add_u32 s96, s96, 1048576
    v_mfma_f32_16x16x32_bf16 v[204:207], v[80:83], v[116:119], v[204:207]
    ds_read_b64_tr_b16 v[80:81], v24 offset:0
    ds_read_b64_tr_b16 v[82:83], v24 offset:1024
    v_mfma_f32_16x16x32_bf16 v[208:211], v[84:87], v[104:107], v[208:211]
    s_mov_b32 s97, 0xffff7fff
    s_mov_b32 s95, 0x3db8aa3b
    v_mfma_f32_16x16x32_bf16 v[212:215], v[84:87], v[108:111], v[212:215]
    buffer_load_dwordx4 v7, s[40:43], s78 offen offset:1024  lds
    s_lshr_b32 s74, s68, 1
    v_mfma_f32_16x16x32_bf16 v[216:219], v[84:87], v[112:115], v[216:219]
    s_add_u32 m0, s83, 147456
    s_mul_i32 s34, s80, 3
    v_mfma_f32_16x16x32_bf16 v[220:223], v[84:87], v[116:119], v[220:223]
    ds_read_b64_tr_b16 v[84:85], v25 offset:0
    ds_read_b64_tr_b16 v[86:87], v25 offset:1024
    v_mfma_f32_16x16x32_bf16 v[224:227], v[48:51], v[104:107], v[224:227]
    s_add_u32 s74, s74, s70
    v_mfma_f32_16x16x32_bf16 v[228:231], v[48:51], v[108:111], v[228:231]
    buffer_load_dwordx4 v10, s[44:47], s34 offen offset:0  lds
    v_mfma_f32_16x16x32_bf16 v[232:235], v[48:51], v[112:115], v[232:235]
    s_cmp_eq_u32 s74, 4
    s_cselect_b32 s76, 0x80000000, 0
    v_mfma_f32_16x16x32_bf16 v[236:239], v[48:51], v[116:119], v[236:239]
    v_add_u32 v0, 640, v40
    v_lshrrev_b32 v0, 10, v0
    v_mfma_f32_16x16x32_bf16 v[240:243], v[52:55], v[104:107], v[240:243]
    v_lshl_add_u32 v0, v0, 7, v40
    v_add_u32 v41, s76, v0
    v_mfma_f32_16x16x32_bf16 v[244:247], v[52:55], v[108:111], v[244:247]
    buffer_load_dwordx4 v11, s[44:47], s34 offen offset:1024  lds
    v_mfma_f32_16x16x32_bf16 v[248:251], v[52:55], v[112:115], v[248:251]
    v_mfma_f32_16x16x32_bf16 v[252:255], v[52:55], v[116:119], v[252:255]
    s_waitcnt vmcnt(14) lgkmcnt(0)
    s_barrier
    s_cmp_lg_u32 s94, 0
    s_cbranch_scc1 L_nolead1
    v_add_u32 v46, 1, v46
    v_max_u32 v46, 1, v46
    s_lshl_b32 s73, s69, 5
    s_lshl_b32 s74, s69, 7
    s_mov_b64 exec, 1
    buffer_store_dword v46, off, s[64:67], s73 sc1
    buffer_store_dword v46, off, s[56:59], s74 sc1
    s_mov_b64 exec, -1
L_nolead1:
    v_mfma_f32_16x16x32_bf16 v[128:131], v[56:59], v[88:91], v[128:131]
    s_add_u32 m0, s81, 49152
    ds_read_b64_tr_b16 v[48:49], v18 offset:16384
    v_mfma_f32_16x16x32_bf16 v[132:135], v[56:59], v[92:95], v[132:135]
    buffer_load_dwordx4 v8, s[40:43], s78 offen offset:2048  lds
    ds_read_b64_tr_b16 v[50:51], v18 offset:17408
    v_mfma_f32_16x16x32_bf16 v[136:139], v[56:59], v[96:99], v[136:139]
    ds_read_b64_tr_b16 v[52:53], v19 offset:16384
    ds_read_b64_tr_b16 v[54:55], v19 offset:17408
    v_mfma_f32_16x16x32_bf16 v[140:143], v[56:59], v[100:103], v[140:143]
    ds_read_b64_tr_b16 v[56:57], v20 offset:16384
    ds_read_b64_tr_b16 v[58:59], v20 offset:17408
    v_mfma_f32_16x16x32_bf16 v[144:147], v[60:63], v[88:91], v[144:147]
    ds_read_b128 v[104:107], v35 offset:0
    v_mfma_f32_16x16x32_bf16 v[148:151], v[60:63], v[92:95], v[148:151]
    buffer_load_dwordx4 v9, s[40:43], s78 offen offset:3072  lds
    v_mfma_f32_16x16x32_bf16 v[152:155], v[60:63], v[96:99], v[152:155]
    s_add_u32 s78, s78, 262144
    s_cmp_eq_u32 s78, 3670016
    s_cselect_b32 s78, 0, s78
    v_mfma_f32_16x16x32_bf16 v[156:159], v[60:63], v[100:103], v[156:159]
    s_add_u32 m0, s81, 0
    ds_read_b64_tr_b16 v[60:61], v21 offset:16384
    v_mfma_f32_16x16x32_bf16 v[160:163], v[64:67], v[88:91], v[160:163]
    ds_read_b64_tr_b16 v[62:63], v21 offset:17408
    ds_read_b128 v[108:111], v35 offset:2048
    v_mfma_f32_16x16x32_bf16 v[164:167], v[64:67], v[92:95], v[164:167]
    buffer_load_dwordx4 v6, s[40:43], s78 offen offset:0  lds
    v_mfma_f32_16x16x32_bf16 v[168:171], v[64:67], v[96:99], v[168:171]
    ds_read_b128 v[112:115], v37 offset:0
    v_mfma_f32_16x16x32_bf16 v[172:175], v[64:67], v[100:103], v[172:175]
    ds_read_b64_tr_b16 v[64:65], v22 offset:16384
    ds_read_b64_tr_b16 v[66:67], v22 offset:17408
    v_mfma_f32_16x16x32_bf16 v[176:179], v[68:71], v[88:91], v[176:179]
    v_mfma_f32_16x16x32_bf16 v[180:183], v[68:71], v[92:95], v[180:183]
    buffer_load_dwordx4 v7, s[40:43], s78 offen offset:1024  lds
    v_mfma_f32_16x16x32_bf16 v[184:187], v[68:71], v[96:99], v[184:187]
    ds_read_b128 v[116:119], v37 offset:2048
    v_mfma_f32_16x16x32_bf16 v[188:191], v[68:71], v[100:103], v[188:191]
    ds_read_b64_tr_b16 v[68:69], v23 offset:16384
    ds_read_b64_tr_b16 v[70:71], v23 offset:17408
    v_mfma_f32_16x16x32_bf16 v[192:195], v[72:75], v[88:91], v[192:195]
    v_mfma_f32_16x16x32_bf16 v[196:199], v[72:75], v[92:95], v[196:199]
    buffer_load_dwordx4 v8, s[40:43], s78 offen offset:2048  lds
    v_mfma_f32_16x16x32_bf16 v[200:203], v[72:75], v[96:99], v[200:203]
    v_mfma_f32_16x16x32_bf16 v[204:207], v[72:75], v[100:103], v[204:207]
    ds_read_b64_tr_b16 v[72:73], v24 offset:16384
    ds_read_b64_tr_b16 v[74:75], v24 offset:17408
    v_mfma_f32_16x16x32_bf16 v[208:211], v[76:79], v[88:91], v[208:211]
    v_mfma_f32_16x16x32_bf16 v[212:215], v[76:79], v[92:95], v[212:215]
    buffer_load_dwordx4 v9, s[40:43], s78 offen offset:3072  lds
    v_mfma_f32_16x16x32_bf16 v[216:219], v[76:79], v[96:99], v[216:219]
    s_add_u32 s78, s78, 262144
    s_cmp_eq_u32 s78, 3670016
    s_cselect_b32 s78, 0, s78
    v_mfma_f32_16x16x32_bf16 v[220:223], v[76:79], v[100:103], v[220:223]
    s_add_u32 m0, s83, 98304
    s_mul_i32 s34, s80, 0
    v_mfma_f32_16x16x32_bf16 v[224:227], v[80:83], v[88:91], v[224:227]
    ds_read_b64_tr_b16 v[76:77], v25 offset:16384
    ds_read_b64_tr_b16 v[78:79], v25 offset:17408
    v_mfma_f32_16x16x32_bf16 v[228:231], v[80:83], v[92:95], v[228:231]
    buffer_load_dwordx4 v12, s[44:47], s34 offen offset:2048  lds
    v_mfma_f32_16x16x32_bf16 v[232:235], v[80:83], v[96:99], v[232:235]
    v_mfma_f32_16x16x32_bf16 v[236:239], v[80:83], v[100:103], v[236:239]
    v_mfma_f32_16x16x32_bf16 v[240:243], v[84:87], v[88:91], v[240:243]
    v_mfma_f32_16x16x32_bf16 v[244:247], v[84:87], v[92:95], v[244:247]
    buffer_load_dwordx4 v13, s[44:47], s34 offen offset:3072  lds
    v_mfma_f32_16x16x32_bf16 v[248:251], v[84:87], v[96:99], v[248:251]
    v_mfma_f32_16x16x32_bf16 v[252:255], v[84:87], v[100:103], v[252:255]
    s_waitcnt vmcnt(12) lgkmcnt(0)
    s_barrier
    v_mfma_f32_16x16x32_bf16 v[128:131], v[48:51], v[104:107], v[128:131]
    s_add_u32 m0, s82, 0
    ds_read_b64_tr_b16 v[80:81], v18 offset:32768
    v_mfma_f32_16x16x32_bf16 v[132:135], v[48:51], v[108:111], v[132:135]
    buffer_load_dwordx4 v2, s[36:39], s79 offen offset:0  lds
    ds_read_b64_tr_b16 v[82:83], v18 offset:33792
    v_mfma_f32_16x16x32_bf16 v[136:139], v[48:51], v[112:115], v[136:139]
    ds_read_b64_tr_b16 v[84:85], v19 offset:32768
    ds_read_b64_tr_b16 v[86:87], v19 offset:33792
    v_mfma_f32_16x16x32_bf16 v[140:143], v[48:51], v[116:119], v[140:143]
    ds_read_b64_tr_b16 v[48:49], v20 offset:32768
    ds_read_b64_tr_b16 v[50:51], v20 offset:33792
    v_mfma_f32_16x16x32_bf16 v[144:147], v[52:55], v[104:107], v[144:147]
    ds_read_b128 v[88:91], v34 offset:16384
    v_mfma_f32_16x16x32_bf16 v[148:151], v[52:55], v[108:111], v[148:151]
    buffer_load_dwordx4 v3, s[36:39], s79 offen offset:1024  lds
    v_mfma_f32_16x16x32_bf16 v[152:155], v[52:55], v[112:115], v[152:155]
    ds_read_b128 v[92:95], v34 offset:18432
    v_mfma_f32_16x16x32_bf16 v[156:159], v[52:55], v[116:119], v[156:159]
    ds_read_b64_tr_b16 v[52:53], v21 offset:32768
    ds_read_b64_tr_b16 v[54:55], v21 offset:33792
    v_mfma_f32_16x16x32_bf16 v[160:163], v[56:59], v[104:107], v[160:163]
    v_mfma_f32_16x16x32_bf16 v[164:167], v[56:59], v[108:111], v[164:167]
    buffer_load_dwordx4 v4, s[36:39], s79 offen offset:2048  lds
    v_mfma_f32_16x16x32_bf16 v[168:171], v[56:59], v[112:115], v[168:171]
    ds_read_b128 v[96:99], v36 offset:16384
    v_mfma_f32_16x16x32_bf16 v[172:175], v[56:59], v[116:119], v[172:175]
    ds_read_b64_tr_b16 v[56:57], v22 offset:32768
    ds_read_b64_tr_b16 v[58:59], v22 offset:33792
    v_mfma_f32_16x16x32_bf16 v[176:179], v[60:63], v[104:107], v[176:179]
    v_mfma_f32_16x16x32_bf16 v[180:183], v[60:63], v[108:111], v[180:183]
    buffer_load_dwordx4 v5, s[36:39], s79 offen offset:3072  lds
    v_mfma_f32_16x16x32_bf16 v[184:187], v[60:63], v[112:115], v[184:187]
    s_add_u32 s79, s79, 128
    s_cmp_eq_u32 s79, 896
    s_cselect_b32 s79, 0, s79
    v_mfma_f32_16x16x32_bf16 v[188:191], v[60:63], v[116:119], v[188:191]
    s_add_u32 m0, s81, 16384
    ds_read_b64_tr_b16 v[60:61], v23 offset:32768
    v_mfma_f32_16x16x32_bf16 v[192:195], v[64:67], v[104:107], v[192:195]
    ds_read_b64_tr_b16 v[62:63], v23 offset:33792
    ds_read_b128 v[100:103], v36 offset:18432
    v_mfma_f32_16x16x32_bf16 v[196:199], v[64:67], v[108:111], v[196:199]
    buffer_load_dwordx4 v6, s[40:43], s78 offen offset:0  lds
    v_mfma_f32_16x16x32_bf16 v[200:203], v[64:67], v[112:115], v[200:203]
    v_mfma_f32_16x16x32_bf16 v[204:207], v[64:67], v[116:119], v[204:207]
    ds_read_b64_tr_b16 v[64:65], v24 offset:32768
    ds_read_b64_tr_b16 v[66:67], v24 offset:33792
    v_mfma_f32_16x16x32_bf16 v[208:211], v[68:71], v[104:107], v[208:211]
    v_mfma_f32_16x16x32_bf16 v[212:215], v[68:71], v[108:111], v[212:215]
    buffer_load_dwordx4 v7, s[40:43], s78 offen offset:1024  lds
    v_mfma_f32_16x16x32_bf16 v[216:219], v[68:71], v[112:115], v[216:219]
    s_add_u32 m0, s83, 114688
    s_mul_i32 s34, s80, 1
    v_mfma_f32_16x16x32_bf16 v[220:223], v[68:71], v[116:119], v[220:223]
    ds_read_b64_tr_b16 v[68:69], v25 offset:32768
    ds_read_b64_tr_b16 v[70:71], v25 offset:33792
    v_mfma_f32_16x16x32_bf16 v[224:227], v[72:75], v[104:107], v[224:227]
    v_mfma_f32_16x16x32_bf16 v[228:231], v[72:75], v[108:111], v[228:231]
    buffer_load_dwordx4 v12, s[44:47], s34 offen offset:2048  lds
    v_mfma_f32_16x16x32_bf16 v[232:235], v[72:75], v[112:115], v[232:235]
    v_mfma_f32_16x16x32_bf16 v[236:239], v[72:75], v[116:119], v[236:239]
    v_mfma_f32_16x16x32_bf16 v[240:243], v[76:79], v[104:107], v[240:243]
    v_mfma_f32_16x16x32_bf16 v[244:247], v[76:79], v[108:111], v[244:247]
    buffer_load_dwordx4 v13, s[44:47], s34 offen offset:3072  lds
    v_mfma_f32_16x16x32_bf16 v[248:251], v[76:79], v[112:115], v[248:251]
    v_mfma_f32_16x16x32_bf16 v[252:255], v[76:79], v[116:119], v[252:255]
    s_waitcnt vmcnt(14) lgkmcnt(0)
    s_barrier
    v_mfma_f32_16x16x32_bf16 v[128:131], v[80:83], v[88:91], v[128:131]
    s_add_u32 m0, s81, 16384
    ds_read_b64_tr_b16 v[72:73], v18 offset:49152
    v_mfma_f32_16x16x32_bf16 v[132:135], v[80:83], v[92:95], v[132:135]
    buffer_load_dwordx4 v8, s[40:43], s78 offen offset:2048  lds
    ds_read_b64_tr_b16 v[74:75], v18 offset:50176
    v_mfma_f32_16x16x32_bf16 v[136:139], v[80:83], v[96:99], v[136:139]
    ds_read_b64_tr_b16 v[76:77], v19 offset:49152
    ds_read_b64_tr_b16 v[78:79], v19 offset:50176
    v_mfma_f32_16x16x32_bf16 v[140:143], v[80:83], v[100:103], v[140:143]
L_pad0:
    s_cbranch_execz L_warm0
    ds_read_b64_tr_b16 v[80:81], v20 offset:49152
    ds_read_b64_tr_b16 v[82:83], v20 offset:50176
    v_mfma_f32_16x16x32_bf16 v[144:147], v[84:87], v[88:91], v[144:147]
    ds_read_b128 v[104:107], v35 offset:16384
    v_mfma_f32_16x16x32_bf16 v[148:151], v[84:87], v[92:95], v[148:151]
    buffer_load_dwordx4 v9, s[40:43], s78 offen offset:3072  lds
    v_mfma_f32_16x16x32_bf16 v[152:155], v[84:87], v[96:99], v[152:155]
    s_add_u32 s78, s78, 262144
    s_cmp_eq_u32 s78, 3670016
    s_cselect_b32 s78, 0, s78
    v_mfma_f32_16x16x32_bf16 v[156:159], v[84:87], v[100:103], v[156:159]
    s_add_u32 m0, s81, 32768
    ds_read_b64_tr_b16 v[84:85], v21 offset:49152
    v_mfma_f32_16x16x32_bf16 v[160:163], v[48:51], v[88:91], v[160:163]
    ds_read_b64_tr_b16 v[86:87], v21 offset:50176
    ds_read_b128 v[108:111], v35 offset:18432
    v_mfma_f32_16x16x32_bf16 v[164:167], v[48:51], v[92:95], v[164:167]
    buffer_load_dwordx4 v6, s[40:43], s78 offen offset:0  lds
    v_mfma_f32_16x16x32_bf16 v[168:171], v[48:51], v[96:99], v[168:171]
    ds_read_b128 v[112:115], v37 offset:16384
    v_mfma_f32_16x16x32_bf16 v[172:175], v[48:51], v[100:103], v[172:175]
    ds_read_b64_tr_b16 v[48:49], v22 offset:49152
    ds_read_b64_tr_b16 v[50:51], v22 offset:50176
    v_mfma_f32_16x16x32_bf16 v[176:179], v[52:55], v[88:91], v[176:179]
    v_mfma_f32_16x16x32_bf16 v[180:183], v[52:55], v[92:95], v[180:183]
    buffer_load_dwordx4 v7, s[40:43], s78 offen offset:1024  lds
    v_mfma_f32_16x16x32_bf16 v[184:187], v[52:55], v[96:99], v[184:187]
    ds_read_b128 v[116:119], v37 offset:18432
    v_mfma_f32_16x16x32_bf16 v[188:191], v[52:55], v[100:103], v[188:191]
    ds_read_b64_tr_b16 v[52:53], v23 offset:49152
    ds_read_b64_tr_b16 v[54:55], v23 offset:50176
    v_mfma_f32_16x16x32_bf16 v[192:195], v[56:59], v[88:91], v[192:195]
    v_mfma_f32_16x16x32_bf16 v[196:199], v[56:59], v[92:95], v[196:199]
    buffer_load_dwordx4 v8, s[40:43], s78 offen offset:2048  lds
    v_mfma_f32_16x16x32_bf16 v[200:203], v[56:59], v[96:99], v[200:203]
    v_mfma_f32_16x16x32_bf16 v[204:207], v[56:59], v[100:103], v[204:207]
    ds_read_b64_tr_b16 v[56:57], v24 offset:49152
    ds_read_b64_tr_b16 v[58:59], v24 offset:50176
    v_mfma_f32_16x16x32_bf16 v[208:211], v[60:63], v[88:91], v[208:211]
    v_mfma_f32_16x16x32_bf16 v[212:215], v[60:63], v[92:95], v[212:215]
    buffer_load_dwordx4 v9, s[40:43], s78 offen offset:3072  lds
    v_mfma_f32_16x16x32_bf16 v[216:219], v[60:63], v[96:99], v[216:219]
    s_add_u32 s78, s78, 262144
    s_cmp_eq_u32 s78, 3670016
    s_cselect_b32 s78, 0, s78
    v_mfma_f32_16x16x32_bf16 v[220:223], v[60:63], v[100:103], v[220:223]
    s_add_u32 m0, s83, 131072
    s_mul_i32 s34, s80, 2
    v_mfma_f32_16x16x32_bf16 v[224:227], v[64:67], v[88:91], v[224:227]
    ds_read_b64_tr_b16 v[60:61], v25 offset:49152
    ds_read_b64_tr_b16 v[62:63], v25 offset:50176
    v_mfma_f32_16x16x32_bf16 v[228:231], v[64:67], v[92:95], v[228:231]
    buffer_load_dwordx4 v12, s[44:47], s34 offen offset:2048  lds
    v_mfma_f32_16x16x32_bf16 v[232:235], v[64:67], v[96:99], v[232:235]
    v_mfma_f32_16x16x32_bf16 v[236:239], v[64:67], v[100:103], v[236:239]
    v_mfma_f32_16x16x32_bf16 v[240:243], v[68:71], v[88:91], v[240:243]
    v_mfma_f32_16x16x32_bf16 v[244:247], v[68:71], v[92:95], v[244:247]
    buffer_load_dwordx4 v13, s[44:47], s34 offen offset:3072  lds
    v_mfma_f32_16x16x32_bf16 v[248:251], v[68:71], v[96:99], v[248:251]
    v_mfma_f32_16x16x32_bf16 v[252:255], v[68:71], v[100:103], v[252:255]
    s_waitcnt vmcnt(12) lgkmcnt(0)
    s_barrier
    v_mfma_f32_16x16x32_bf16 v[128:131], v[72:75], v[104:107], v[128:131]
    s_add_u32 m0, s82, 16384
    ds_read_b64_tr_b16 v[64:65], v18 offset:0
    v_mfma_f32_16x16x32_bf16 v[132:135], v[72:75], v[108:111], v[132:135]
    buffer_load_dwordx4 v2, s[36:39], s79 offen offset:0  lds
    ds_read_b64_tr_b16 v[66:67], v18 offset:1024
    v_mfma_f32_16x16x32_bf16 v[136:139], v[72:75], v[112:115], v[136:139]
    ds_read_b64_tr_b16 v[68:69], v19 offset:0
    ds_read_b64_tr_b16 v[70:71], v19 offset:1024
    v_mfma_f32_16x16x32_bf16 v[140:143], v[72:75], v[116:119], v[140:143]
    ds_read_b64_tr_b16 v[72:73], v20 offset:0
    ds_read_b64_tr_b16 v[74:75], v20 offset:1024
    v_mfma_f32_16x16x32_bf16 v[144:147], v[76:79], v[104:107], v[144:147]
    ds_read_b128 v[88:91], v34 offset:0
    v_mfma_f32_16x16x32_bf16 v[148:151], v[76:79], v[108:111], v[148:151]
    buffer_load_dwordx4 v3, s[36:39], s79 offen offset:1024  lds
    v_mfma_f32_16x16x32_bf16 v[152:155], v[76:79], v[112:115], v[152:155]
    ds_read_b128 v[92:95], v34 offset:2048
    v_mfma_f32_16x16x32_bf16 v[156:159], v[76:79], v[116:119], v[156:159]
    ds_read_b64_tr_b16 v[76:77], v21 offset:0
    ds_read_b64_tr_b16 v[78:79], v21 offset:1024
    v_mfma_f32_16x16x32_bf16 v[160:163], v[80:83], v[104:107], v[160:163]
    v_mfma_f32_16x16x32_bf16 v[164:167], v[80:83], v[108:111], v[164:167]
    buffer_load_dwordx4 v4, s[36:39], s79 offen offset:2048  lds
    v_mfma_f32_16x16x32_bf16 v[168:171], v[80:83], v[112:115], v[168:171]
    ds_read_b128 v[96:99], v36 offset:0
    v_mfma_f32_16x16x32_bf16 v[172:175], v[80:83], v[116:119], v[172:175]
    ds_read_b64_tr_b16 v[80:81], v22 offset:0
    ds_read_b64_tr_b16 v[82:83], v22 offset:1024
    v_mfma_f32_16x16x32_bf16 v[176:179], v[84:87], v[104:107], v[176:179]
    v_mfma_f32_16x16x32_bf16 v[180:183], v[84:87], v[108:111], v[180:183]
    buffer_load_dwordx4 v5, s[36:39], s79 offen offset:3072  lds
    v_mfma_f32_16x16x32_bf16 v[184:187], v[84:87], v[112:115], v[184:187]
    s_add_u32 s79, s79, 128
    s_cmp_eq_u32 s79, 896
    s_cselect_b32 s79, 0, s79
    v_mfma_f32_16x16x32_bf16 v[188:191], v[84:87], v[116:119], v[188:191]
    s_add_u32 m0, s81, 49152
    ds_read_b64_tr_b16 v[84:85], v23 offset:0
    v_mfma_f32_16x16x32_bf16 v[192:195], v[48:51], v[104:107], v[192:195]
    ds_read_b64_tr_b16 v[86:87], v23 offset:1024
    ds_read_b128 v[100:103], v36 offset:2048
    v_mfma_f32_16x16x32_bf16 v[196:199], v[48:51], v[108:111], v[196:199]
    buffer_load_dwordx4 v6, s[40:43], s78 offen offset:0  lds
    v_mfma_f32_16x16x32_bf16 v[200:203], v[48:51], v[112:115], v[200:203]
    v_mfma_f32_16x16x32_bf16 v[204:207], v[48:51], v[116:119], v[204:207]
    ds_read_b64_tr_b16 v[48:49], v24 offset:0
    ds_read_b64_tr_b16 v[50:51], v24 offset:1024
    v_mfma_f32_16x16x32_bf16 v[208:211], v[52:55], v[104:107], v[208:211]
    v_mfma_f32_16x16x32_bf16 v[212:215], v[52:55], v[108:111], v[212:215]
    buffer_load_dwordx4 v7, s[40:43], s78 offen offset:1024  lds
    v_mfma_f32_16x16x32_bf16 v[216:219], v[52:55], v[112:115], v[216:219]
    s_add_u32 m0, s83, 147456
    s_mul_i32 s34, s80, 3
    v_mfma_f32_16x16x32_bf16 v[220:223], v[52:55], v[116:119], v[220:223]
    ds_read_b64_tr_b16 v[52:53], v25 offset:0
    ds_read_b64_tr_b16 v[54:55], v25 offset:1024
    v_mfma_f32_16x16x32_bf16 v[224:227], v[56:59], v[104:107], v[224:227]
    v_mfma_f32_16x16x32_bf16 v[228:231], v[56:59], v[108:111], v[228:231]
    buffer_load_dwordx4 v12, s[44:47], s34 offen offset:2048  lds
    v_mfma_f32_16x16x32_bf16 v[232:235], v[56:59], v[112:115], v[232:235]
    v_mfma_f32_16x16x32_bf16 v[236:239], v[56:59], v[116:119], v[236:239]
    v_mfma_f32_16x16x32_bf16 v[240:243], v[60:63], v[104:107], v[240:243]
    v_mfma_f32_16x16x32_bf16 v[244:247], v[60:63], v[108:111], v[244:247]
    buffer_load_dwordx4 v13, s[44:47], s34 offen offset:3072  lds
    v_mfma_f32_16x16x32_bf16 v[248:251], v[60:63], v[112:115], v[248:251]
    v_mfma_f32_16x16x32_bf16 v[252:255], v[60:63], v[116:119], v[252:255]
    s_waitcnt vmcnt(14) lgkmcnt(0)
    s_barrier
    v_mfma_f32_16x16x32_bf16 v[128:131], v[64:67], v[88:91], v[128:131]
    s_add_u32 m0, s81, 49152
    ds_read_b64_tr_b16 v[56:57], v18 offset:16384
    v_mfma_f32_16x16x32_bf16 v[132:135], v[64:67], v[92:95], v[132:135]
    buffer_load_dwordx4 v8, s[40:43], s78 offen offset:2048  lds
    ds_read_b64_tr_b16 v[58:59], v18 offset:17408
    v_mfma_f32_16x16x32_bf16 v[136:139], v[64:67], v[96:99], v[136:139]
    ds_read_b64_tr_b16 v[60:61], v19 offset:16384
    ds_read_b64 a[192:193], v120 offset:0
    v_mfma_f32_16x16x32_bf16 v[140:143], v[64:67], v[100:103], v[140:143]
    ds_read_b64_tr_b16 v[62:63], v19 offset:17408
    ds_read_b64 a[194:195], v121 offset:0
    v_mfma_f32_16x16x32_bf16 v[144:147], v[68:71], v[88:91], v[144:147]
    ds_read_b64_tr_b16 v[64:65], v20 offset:16384
    ds_read_b64 a[196:197], v122 offset:0
    v_mfma_f32_16x16x32_bf16 v[148:151], v[68:71], v[92:95], v[148:151]
    buffer_load_dwordx4 v9, s[40:43], s78 offen offset:3072  lds
    ds_read_b64_tr_b16 v[66:67], v20 offset:17408
    v_mfma_f32_16x16x32_bf16 v[152:155], v[68:71], v[96:99], v[152:155]
    s_add_u32 s78, s78, 262144
    s_cmp_eq_u32 s78, 3670016
    s_cselect_b32 s78, 0, s78
    v_mfma_f32_16x16x32_bf16 v[156:159], v[68:71], v[100:103], v[156:159]
    s_add_u32 m0, s81, 0
    ds_read_b64 a[198:199], v123 offset:0
    v_mfma_f32_16x16x32_bf16 v[160:163], v[72:75], v[88:91], v[160:163]
    ds_read_b64_tr_b16 v[68:69], v21 offset:16384
    ds_read_b64 a[200:201], v120 offset:4096
    v_mfma_f32_16x16x32_bf16 v[164:167], v[72:75], v[92:95], v[164:167]
    buffer_load_dwordx4 v6, s[40:43], s78 offen offset:0  lds
    ds_read_b64_tr_b16 v[70:71], v21 offset:17408
    v_mfma_f32_16x16x32_bf16 v[168:171], v[72:75], v[96:99], v[168:171]
    ds_read_b64 a[202:203], v121 offset:4096
    ds_read_b64 a[204:205], v122 offset:4096
    v_mfma_f32_16x16x32_bf16 v[172:175], v[72:75], v[100:103], v[172:175]
    ds_read_b64_tr_b16 v[72:73], v22 offset:16384
    ds_read_b64_tr_b16 v[74:75], v22 offset:17408
    v_mfma_f32_16x16x32_bf16 v[176:179], v[76:79], v[88:91], v[176:179]
    ds_read_b64 a[206:207], v123 offset:4096
    ds_read_b64 a[224:225], v124 offset:0
    v_mfma_f32_16x16x32_bf16 v[180:183], v[76:79], v[92:95], v[180:183]
    buffer_load_dwordx4 v7, s[40:43], s78 offen offset:1024  lds
    ds_read_b64 a[226:227], v125 offset:0
    v_mfma_f32_16x16x32_bf16 v[184:187], v[76:79], v[96:99], v[184:187]
    ds_read_b128 v[104:107], v35 offset:0
    ds_read_b64 a[228:229], v126 offset:0
    v_mfma_f32_16x16x32_bf16 v[188:191], v[76:79], v[100:103], v[188:191]
    ds_read_b64_tr_b16 v[76:77], v23 offset:16384
    ds_read_b64_tr_b16 v[78:79], v23 offset:17408
    v_mfma_f32_16x16x32_bf16 v[192:195], v[80:83], v[88:91], v[192:195]
    ds_read_b128 v[108:111], v35 offset:2048
    ds_read_b64 a[230:231], v127 offset:0
    v_mfma_f32_16x16x32_bf16 v[196:199], v[80:83], v[92:95], v[196:199]
    buffer_load_dwordx4 v8, s[40:43], s78 offen offset:2048  lds
    ds_read_b128 v[112:115], v37 offset:0
    v_mfma_f32_16x16x32_bf16 v[200:203], v[80:83], v[96:99], v[200:203]
    ds_read_b64 a[232:233], v124 offset:4096
    ds_read_b64 a[234:235], v125 offset:4096
    v_mfma_f32_16x16x32_bf16 v[204:207], v[80:83], v[100:103], v[204:207]
    ds_read_b64_tr_b16 v[80:81], v24 offset:16384
    ds_read_b64_tr_b16 v[82:83], v24 offset:17408
    v_mfma_f32_16x16x32_bf16 v[208:211], v[84:87], v[88:91], v[208:211]
    ds_read_b128 v[116:119], v37 offset:2048
    v_mfma_f32_16x16x32_bf16 v[212:215], v[84:87], v[92:95], v[212:215]
    buffer_load_dwordx4 v9, s[40:43], s78 offen offset:3072  lds
    ds_read_b64 a[236:237], v126 offset:4096
    v_mfma_f32_16x16x32_bf16 v[216:219], v[84:87], v[96:99], v[216:219]
    s_add_u32 s78, s78, 262144
    s_cmp_eq_u32 s78, 3670016
    s_cselect_b32 s78, 0, s78
    v_mfma_f32_16x16x32_bf16 v[220:223], v[84:87], v[100:103], v[220:223]
    s_lshl_b32 s74, s69, 5
    s_cmp_lg_u32 s68, 0
    s_cbranch_scc1 L_non0
    buffer_load_dword v47, off, s[64:67], s74 sc1
L_non0:
    v_mfma_f32_16x16x32_bf16 v[224:227], v[48:51], v[88:91], v[224:227]
    ds_read_b64_tr_b16 v[84:85], v25 offset:16384
    ds_read_b64_tr_b16 v[86:87], v25 offset:17408
    v_mfma_f32_16x16x32_bf16 v[228:231], v[48:51], v[92:95], v[228:231]
    ds_read_b64 a[238:239], v127 offset:4096
    v_mfma_f32_16x16x32_bf16 v[232:235], v[48:51], v[96:99], v[232:235]
    v_mfma_f32_16x16x32_bf16 v[236:239], v[48:51], v[100:103], v[236:239]
    v_mfma_f32_16x16x32_bf16 v[240:243], v[52:55], v[88:91], v[240:243]
    v_mfma_f32_16x16x32_bf16 v[244:247], v[52:55], v[92:95], v[244:247]
    v_mfma_f32_16x16x32_bf16 v[248:251], v[52:55], v[96:99], v[248:251]
    v_mfma_f32_16x16x32_bf16 v[252:255], v[52:55], v[100:103], v[252:255]
    s_waitcnt vmcnt(10) lgkmcnt(0)
    s_barrier
    v_mfma_f32_16x16x32_bf16 v[128:131], v[56:59], v[104:107], v[128:131]
    s_add_u32 m0, s82, 0
    ds_read_b64_tr_b16 v[48:49], v18 offset:32768
    v_mfma_f32_16x16x32_bf16 v[132:135], v[56:59], v[108:111], v[132:135]
    buffer_load_dwordx4 v2, s[36:39], s79 offen offset:0  lds
    ds_read_b64_tr_b16 v[50:51], v18 offset:33792
    v_mfma_f32_16x16x32_bf16 v[136:139], v[56:59], v[112:115], v[136:139]
    ds_read_b64_tr_b16 v[52:53], v19 offset:32768
    ds_read_b64_tr_b16 v[54:55], v19 offset:33792
    v_mfma_f32_16x16x32_bf16 v[140:143], v[56:59], v[116:119], v[140:143]
    ds_read_b64_tr_b16 v[56:57], v20 offset:32768
    ds_read_b64_tr_b16 v[58:59], v20 offset:33792
    v_mfma_f32_16x16x32_bf16 v[144:147], v[60:63], v[104:107], v[144:147]
    ds_read_b128 v[88:91], v34 offset:16384
    v_mfma_f32_16x16x32_bf16 v[148:151], v[60:63], v[108:111], v[148:151]
    buffer_load_dwordx4 v3, s[36:39], s79 offen offset:1024  lds
    v_mfma_f32_16x16x32_bf16 v[152:155], v[60:63], v[112:115], v[152:155]
    ds_read_b128 v[92:95], v34 offset:18432
    v_mfma_f32_16x16x32_bf16 v[156:159], v[60:63], v[116:119], v[156:159]
    ds_read_b64_tr_b16 v[60:61], v21 offset:32768
    ds_read_b64_tr_b16 v[62:63], v21 offset:33792
    v_mfma_f32_16x16x32_bf16 v[160:163], v[64:67], v[104:107], v[160:163]
    v_mfma_f32_16x16x32_bf16 v[164:167], v[64:67], v[108:111], v[164:167]
    buffer_load_dwordx4 v4, s[36:39], s79 offen offset:2048  lds
    v_mfma_f32_16x16x32_bf16 v[168:171], v[64:67], v[112:115], v[168:171]
    ds_read_b128 v[96:99], v36 offset:16384
    v_mfma_f32_16x16x32_bf16 v[172:175], v[64:67], v[116:119], v[172:175]
    ds_read_b64_tr_b16 v[64:65], v22 offset:32768
    ds_read_b64_tr_b16 v[66:67], v22 offset:33792
    v_mfma_f32_16x16x32_bf16 v[176:179], v[68:71], v[104:107], v[176:179]
    v_mfma_f32_16x16x32_bf16 v[180:183], v[68:71], v[108:111], v[180:183]
    buffer_load_dwordx4 v5, s[36:39], s79 offen offset:3072  lds
    v_mfma_f32_16x16x32_bf16 v[184:187], v[68:71], v[112:115], v[184:187]
    s_add_u32 s79, s79, 128
    s_cmp_eq_u32 s79, 896
    s_cselect_b32 s79, 0, s79
    v_mfma_f32_16x16x32_bf16 v[188:191], v[68:71], v[116:119], v[188:191]
    s_add_u32 m0, s81, 16384
    ds_read_b64_tr_b16 v[68:69], v23 offset:32768
    v_mfma_f32_16x16x32_bf16 v[192:195], v[72:75], v[104:107], v[192:195]
    ds_read_b64_tr_b16 v[70:71], v23 offset:33792
    ds_read_b128 v[100:103], v36 offset:18432
    v_mfma_f32_16x16x32_bf16 v[196:199], v[72:75], v[108:111], v[196:199]
    buffer_load_dwordx4 v6, s[40:43], s78 offen offset:0  lds
    v_mfma_f32_16x16x32_bf16 v[200:203], v[72:75], v[112:115], v[200:203]
    v_mfma_f32_16x16x32_bf16 v[204:207], v[72:75], v[116:119], v[204:207]
    ds_read_b64_tr_b16 v[72:73], v24 offset:32768
    ds_read_b64_tr_b16 v[74:75], v24 offset:33792
    v_mfma_f32_16x16x32_bf16 v[208:211], v[76:79], v[104:107], v[208:211]
    v_mfma_f32_16x16x32_bf16 v[212:215], v[76:79], v[108:111], v[212:215]
    buffer_load_dwordx4 v7, s[40:43], s78 offen offset:1024  lds
    v_mfma_f32_16x16x32_bf16 v[216:219], v[76:79], v[112:115], v[216:219]
    v_mfma_f32_16x16x32_bf16 v[220:223], v[76:79], v[116:119], v[220:223]
    ds_read_b64_tr_b16 v[76:77], v25 offset:32768
    ds_read_b64_tr_b16 v[78:79], v25 offset:33792
    v_mfma_f32_16x16x32_bf16 v[224:227], v[80:83], v[104:107], v[224:227]
    v_mfma_f32_16x16x32_bf16 v[228:231], v[80:83], v[108:111], v[228:231]
    v_mfma_f32_16x16x32_bf16 v[232:235], v[80:83], v[112:115], v[232:235]
    v_mfma_f32_16x16x32_bf16 v[236:239], v[80:83], v[116:119], v[236:239]
    v_mfma_f32_16x16x32_bf16 v[240:243], v[84:87], v[104:107], v[240:243]
    v_mfma_f32_16x16x32_bf16 v[244:247], v[84:87], v[108:111], v[244:247]
    v_mfma_f32_16x16x32_bf16 v[248:251], v[84:87], v[112:115], v[248:251]
    v_mfma_f32_16x16x32_bf16 v[252:255], v[84:87], v[116:119], v[252:255]
    s_waitcnt vmcnt(10) lgkmcnt(0)
    s_barrier
    v_mfma_f32_16x16x32_bf16 v[128:131], v[48:51], v[88:91], v[128:131]
    s_add_u32 m0, s81, 16384
    ds_read_b64_tr_b16 v[80:81], v18 offset:49152
    v_mfma_f32_16x16x32_bf16 v[132:135], v[48:51], v[92:95], v[132:135]
    buffer_load_dwordx4 v8, s[40:43], s78 offen offset:2048  lds
    ds_read_b64_tr_b16 v[82:83], v18 offset:50176
    v_mfma_f32_16x16x32_bf16 v[136:139], v[48:51], v[96:99], v[136:139]
    ds_read_b64_tr_b16 v[84:85], v19 offset:49152
    ds_read_b64 a[208:209], v120 offset:2048
    v_mfma_f32_16x16x32_bf16 v[140:143], v[48:51], v[100:103], v[140:143]
    ds_read_b64_tr_b16 v[86:87], v19 offset:50176
    ds_read_b64 a[210:211], v121 offset:2048
    v_mfma_f32_16x16x32_bf16 v[144:147], v[52:55], v[88:91], v[144:147]
    ds_read_b64_tr_b16 v[48:49], v20 offset:49152
    ds_read_b64 a[212:213], v122 offset:2048
    v_mfma_f32_16x16x32_bf16 v[148:151], v[52:55], v[92:95], v[148:151]
    buffer_load_dwordx4 v9, s[40:43], s78 offen offset:3072  lds
    ds_read_b64_tr_b16 v[50:51], v20 offset:50176
    v_mfma_f32_16x16x32_bf16 v[152:155], v[52:55], v[96:99], v[152:155]
    s_add_u32 s78, s78, 262144
    s_cmp_eq_u32 s78, 3670016
    s_cselect_b32 s78, 0, s78
    v_mfma_f32_16x16x32_bf16 v[156:159], v[52:55], v[100:103], v[156:159]
    s_add_u32 m0, s83, 32768
    ds_read_b64 a[214:215], v123 offset:2048
    v_mfma_f32_16x16x32_bf16 v[160:163], v[56:59], v[88:91], v[160:163]
    ds_read_b64_tr_b16 v[52:53], v21 offset:49152
    ds_read_b64 a[216:217], v120 offset:6144
    v_mfma_f32_16x16x32_bf16 v[164:167], v[56:59], v[92:95], v[164:167]
    buffer_load_dwordx4 v14, s[48:51], s92 offen offset:0  lds
    ds_read_b64_tr_b16 v[54:55], v21 offset:50176
    v_mfma_f32_16x16x32_bf16 v[168:171], v[56:59], v[96:99], v[168:171]
    ds_read_b64 a[218:219], v121 offset:6144
    ds_read_b64 a[220:221], v122 offset:6144
    v_mfma_f32_16x16x32_bf16 v[172:175], v[56:59], v[100:103], v[172:175]
    ds_read_b64_tr_b16 v[56:57], v22 offset:49152
    ds_read_b64_tr_b16 v[58:59], v22 offset:50176
    v_mfma_f32_16x16x32_bf16 v[176:179], v[60:63], v[88:91], v[176:179]
    ds_read_b64 a[222:223], v123 offset:6144
    ds_read_b64 a[240:241], v124 offset:2048
    v_mfma_f32_16x16x32_bf16 v[180:183], v[60:63], v[92:95], v[180:183]
    buffer_load_dwordx4 v15, s[48:51], s92 offen offset:1024  lds
    ds_read_b64 a[242:243], v125 offset:2048
    v_mfma_f32_16x16x32_bf16 v[184:187], v[60:63], v[96:99], v[184:187]
    ds_read_b128 v[104:107], v35 offset:16384
    ds_read_b64 a[244:245], v126 offset:2048
    v_mfma_f32_16x16x32_bf16 v[188:191], v[60:63], v[100:103], v[188:191]
    ds_read_b64_tr_b16 v[60:61], v23 offset:49152
    ds_read_b64_tr_b16 v[62:63], v23 offset:50176
    v_mfma_f32_16x16x32_bf16 v[192:195], v[64:67], v[88:91], v[192:195]
    ds_read_b128 v[108:111], v35 offset:18432
    ds_read_b64 a[246:247], v127 offset:2048
    v_mfma_f32_16x16x32_bf16 v[196:199], v[64:67], v[92:95], v[196:199]
    buffer_load_dwordx4 v16, s[48:51], s92 offen offset:2048  lds
    ds_read_b128 v[112:115], v37 offset:16384
    v_mfma_f32_16x16x32_bf16 v[200:203], v[64:67], v[96:99], v[200:203]
    ds_read_b64 a[248:249], v124 offset:6144
    ds_read_b64 a[250:251], v125 offset:6144
    v_mfma_f32_16x16x32_bf16 v[204:207], v[64:67], v[100:103], v[204:207]
    ds_read_b64_tr_b16 v[64:65], v24 offset:49152
    ds_read_b64_tr_b16 v[66:67], v24 offset:50176
    v_mfma_f32_16x16x32_bf16 v[208:211], v[68:71], v[88:91], v[208:211]
    ds_read_b128 v[116:119], v37 offset:18432
    v_mfma_f32_16x16x32_bf16 v[212:215], v[68:71], v[92:95], v[212:215]
    buffer_load_dwordx4 v17, s[48:51], s92 offen offset:3072  lds
    s_add_u32 s92, s92, 14336
    v_mfma_f32_16x16x32_bf16 v[216:219], v[68:71], v[96:99], v[216:219]
    ds_read_b64 a[252:253], v126 offset:6144
    ds_read_b64 a[254:255], v127 offset:6144
    v_mfma_f32_16x16x32_bf16 v[220:223], v[68:71], v[100:103], v[220:223]
    ds_read_b64_tr_b16 v[68:69], v25 offset:49152
    ds_read_b64_tr_b16 v[70:71], v25 offset:50176
    v_mfma_f32_16x16x32_bf16 v[224:227], v[72:75], v[88:91], v[224:227]
    v_mfma_f32_16x16x32_bf16 v[228:231], v[72:75], v[92:95], v[228:231]
    v_mfma_f32_16x16x32_bf16 v[232:235], v[72:75], v[96:99], v[232:235]
    v_mfma_f32_16x16x32_bf16 v[236:239], v[72:75], v[100:103], v[236:239]
    v_mfma_f32_16x16x32_bf16 v[240:243], v[76:79], v[88:91], v[240:243]
    v_mfma_f32_16x16x32_bf16 v[244:247], v[76:79], v[92:95], v[244:247]
    v_mfma_f32_16x16x32_bf16 v[248:251], v[76:79], v[96:99], v[248:251]
    v_mfma_f32_16x16x32_bf16 v[252:255], v[76:79], v[100:103], v[252:255]
    s_waitcnt vmcnt(8) lgkmcnt(0)
    s_barrier
    s_cmp_lg_u32 s68, 0
    s_cbranch_scc1 L_non1
    s_lshl_b32 s74, s69, 5
    s_mov_b32 s75, 0
L_non_spin:
    v_readfirstlane_b32 s73, v47
    s_nop 3
    s_cmp_lg_u32 s73, 0
    s_cbranch_scc1 L_non_ok
    s_add_u32 s75, s75, 1
    s_cmp_ge_u32 s75, 0x40000
    s_cbranch_scc1 L_non_ok
    buffer_load_dword v47, off, s[64:67], s74 sc1
    s_waitcnt vmcnt(0)
    s_branch L_non_spin
L_non_ok:
    v_mov_b32 v42, 81920
    ds_write_b32 v42, v47
L_non1:
    v_mfma_f32_16x16x32_bf16 v[128:131], v[80:83], v[104:107], v[128:131]
    s_add_u32 m0, s83, 49152
    ds_read_b64_tr_b16 v[72:73], v18 offset:0
    v_mfma_f32_16x16x32_bf16 v[132:135], v[80:83], v[108:111], v[132:135]
    buffer_load_dwordx4 v14, s[48:51], s92 offen offset:0  lds
    ds_read_b64_tr_b16 v[74:75], v18 offset:1024
    v_mfma_f32_16x16x32_bf16 v[136:139], v[80:83], v[112:115], v[136:139]
    ds_read_b64_tr_b16 v[76:77], v19 offset:0
    ds_read_b64_tr_b16 v[78:79], v19 offset:1024
    v_mfma_f32_16x16x32_bf16 v[140:143], v[80:83], v[116:119], v[140:143]
    ds_read_b64_tr_b16 v[80:81], v20 offset:0
    ds_read_b64_tr_b16 v[82:83], v20 offset:1024
    v_mfma_f32_16x16x32_bf16 v[144:147], v[84:87], v[104:107], v[144:147]
    ds_read_b128 v[88:91], v34 offset:0
    v_add_u32 v120, 98304, v26
    v_mfma_f32_16x16x32_bf16 v[148:151], v[84:87], v[108:111], v[148:151]
    buffer_load_dwordx4 v15, s[48:51], s92 offen offset:1024  lds
    v_add_u32 v121, 98304, v27
    v_mfma_f32_16x16x32_bf16 v[152:155], v[84:87], v[112:115], v[152:155]
    ds_read_b128 v[92:95], v34 offset:2048
    v_add_u32 v122, 98304, v28
    v_mfma_f32_16x16x32_bf16 v[156:159], v[84:87], v[116:119], v[156:159]
    ds_read_b64_tr_b16 v[84:85], v21 offset:0
    ds_read_b64_tr_b16 v[86:87], v21 offset:1024
    v_mfma_f32_16x16x32_bf16 v[160:163], v[48:51], v[104:107], v[160:163]
    v_add_u32 v123, 98304, v29
    v_add_u32 v124, 98304, v30
    v_mfma_f32_16x16x32_bf16 v[164:167], v[48:51], v[108:111], v[164:167]
    buffer_load_dwordx4 v16, s[48:51], s92 offen offset:2048  lds
    v_add_u32 v125, 98304, v31
    v_mfma_f32_16x16x32_bf16 v[168:171], v[48:51], v[112:115], v[168:171]
    ds_read_b128 v[96:99], v36 offset:0
    v_add_u32 v126, 98304, v32
    v_mfma_f32_16x16x32_bf16 v[172:175], v[48:51], v[116:119], v[172:175]
    ds_read_b64_tr_b16 v[48:49], v22 offset:0
    ds_read_b64_tr_b16 v[50:51], v22 offset:1024
    v_mfma_f32_16x16x32_bf16 v[176:179], v[52:55], v[104:107], v[176:179]
    v_add_u32 v127, 98304, v33
    v_mfma_f32_16x16x32_bf16 v[180:183], v[52:55], v[108:111], v[180:183]
    buffer_load_dwordx4 v17, s[48:51], s92 offen offset:3072  lds
    s_add_u32 s92, s92, 14336
    v_mfma_f32_16x16x32_bf16 v[184:187], v[52:55], v[112:115], v[184:187]
    s_add_u32 m0, s83, 98304
    ds_read_b128 v[100:103], v36 offset:2048
    v_mfma_f32_16x16x32_bf16 v[188:191], v[52:55], v[116:119], v[188:191]
    ds_read_b64_tr_b16 v[52:53], v23 offset:0
    ds_read_b64_tr_b16 v[54:55], v23 offset:1024
    v_mfma_f32_16x16x32_bf16 v[192:195], v[56:59], v[104:107], v[192:195]
    v_mfma_f32_16x16x32_bf16 v[196:199], v[56:59], v[108:111], v[196:199]
    buffer_load_dwordx4 v14, s[48:51], s92 offen offset:0  lds
    v_mfma_f32_16x16x32_bf16 v[200:203], v[56:59], v[112:115], v[200:203]
    v_mfma_f32_16x16x32_bf16 v[204:207], v[56:59], v[116:119], v[204:207]
    ds_read_b64_tr_b16 v[56:57], v24 offset:0
    ds_read_b64_tr_b16 v[58:59], v24 offset:1024
    v_mfma_f32_16x16x32_bf16 v[208:211], v[60:63], v[104:107], v[208:211]
    v_mfma_f32_16x16x32_bf16 v[212:215], v[60:63], v[108:111], v[212:215]
    buffer_load_dwordx4 v15, s[48:51], s92 offen offset:1024  lds
    v_mfma_f32_16x16x32_bf16 v[216:219], v[60:63], v[112:115], v[216:219]
    v_mfma_f32_16x16x32_bf16 v[220:223], v[60:63], v[116:119], v[220:223]
    ds_read_b64_tr_b16 v[60:61], v25 offset:0
    ds_read_b64_tr_b16 v[62:63], v25 offset:1024
    v_mfma_f32_16x16x32_bf16 v[224:227], v[64:67], v[104:107], v[224:227]
    v_mfma_f32_16x16x32_bf16 v[228:231], v[64:67], v[108:111], v[228:231]
    buffer_load_dwordx4 v16, s[48:51], s92 offen offset:2048  lds
    v_mfma_f32_16x16x32_bf16 v[232:235], v[64:67], v[112:115], v[232:235]
    v_mfma_f32_16x16x32_bf16 v[236:239], v[64:67], v[116:119], v[236:239]
    v_mfma_f32_16x16x32_bf16 v[240:243], v[68:71], v[104:107], v[240:243]
    v_mfma_f32_16x16x32_bf16 v[244:247], v[68:71], v[108:111], v[244:247]
    buffer_load_dwordx4 v17, s[48:51], s92 offen offset:3072  lds
    s_add_u32 s92, s92, 14336
    v_mfma_f32_16x16x32_bf16 v[248:251], v[68:71], v[112:115], v[248:251]
    v_mfma_f32_16x16x32_bf16 v[252:255], v[68:71], v[116:119], v[252:255]
    s_waitcnt vmcnt(12) lgkmcnt(0)
    s_barrier
    v_mfma_f32_16x16x32_bf16 v[128:131], v[72:75], v[88:91], v[128:131]
    s_add_u32 m0, s83, 114688
    ds_read_b64_tr_b16 v[64:65], v18 offset:16384
    v_mfma_f32_16x16x32_bf16 v[132:135], v[72:75], v[92:95], v[132:135]
    buffer_load_dwordx4 v14, s[48:51], s92 offen offset:0  lds
    ds_read_b64_tr_b16 v[66:67], v18 offset:17408
    v_mfma_f32_16x16x32_bf16 v[136:139], v[72:75], v[96:99], v[136:139]
    ds_read_b64_tr_b16 v[68:69], v19 offset:16384
    ds_read_b64_tr_b16 v[70:71], v19 offset:17408
    v_mfma_f32_16x16x32_bf16 v[140:143], v[72:75], v[100:103], v[140:143]
    ds_read_b64_tr_b16 v[72:73], v20 offset:16384
    ds_read_b64_tr_b16 v[74:75], v20 offset:17408
    v_mfma_f32_16x16x32_bf16 v[144:147], v[76:79], v[88:91], v[144:147]
    ds_read_b128 v[104:107], v35 offset:0
    v_mfma_f32_16x16x32_bf16 v[148:151], v[76:79], v[92:95], v[148:151]
    buffer_load_dwordx4 v15, s[48:51], s92 offen offset:1024  lds
    v_mfma_f32_16x16x32_bf16 v[152:155], v[76:79], v[96:99], v[152:155]
    ds_read_b128 v[108:111], v35 offset:2048
    v_mfma_f32_16x16x32_bf16 v[156:159], v[76:79], v[100:103], v[156:159]
    ds_read_b64_tr_b16 v[76:77], v21 offset:16384
    ds_read_b64_tr_b16 v[78:79], v21 offset:17408
    v_mfma_f32_16x16x32_bf16 v[160:163], v[80:83], v[88:91], v[160:163]
    v_mfma_f32_16x16x32_bf16 v[164:167], v[80:83], v[92:95], v[164:167]
    buffer_load_dwordx4 v16, s[48:51], s92 offen offset:2048  lds
    v_mfma_f32_16x16x32_bf16 v[168:171], v[80:83], v[96:99], v[168:171]
    ds_read_b128 v[112:115], v37 offset:0
    v_mfma_f32_16x16x32_bf16 v[172:175], v[80:83], v[100:103], v[172:175]
    ds_read_b64_tr_b16 v[80:81], v22 offset:16384
    ds_read_b64_tr_b16 v[82:83], v22 offset:17408
    v_mfma_f32_16x16x32_bf16 v[176:179], v[84:87], v[88:91], v[176:179]
    v_mfma_f32_16x16x32_bf16 v[180:183], v[84:87], v[92:95], v[180:183]
    buffer_load_dwordx4 v17, s[48:51], s92 offen offset:3072  lds
    v_mfma_f32_16x16x32_bf16 v[184:187], v[84:87], v[96:99], v[184:187]
    s_add_u32 s92, s92, 14336
    s_cmp_eq_u32 s92, 229376
    s_cselect_b32 s92, 0, s92
    v_mfma_f32_16x16x32_bf16 v[188:191], v[84:87], v[100:103], v[188:191]
    s_add_u32 m0, s83, 131072
    s_add_u32 s34, s88, s84
    v_mfma_f32_16x16x32_bf16 v[192:195], v[48:51], v[88:91], v[192:195]
    ds_read_b64_tr_b16 v[84:85], v23 offset:16384
    ds_read_b64_tr_b16 v[86:87], v23 offset:17408
    v_mfma_f32_16x16x32_bf16 v[196:199], v[48:51], v[92:95], v[196:199]
    buffer_load_dwordx4 v10, s[52:55], s34 offen offset:0  lds
    ds_read_b128 v[116:119], v37 offset:2048
    v_mfma_f32_16x16x32_bf16 v[200:203], v[48:51], v[96:99], v[200:203]
    v_mfma_f32_16x16x32_bf16 v[204:207], v[48:51], v[100:103], v[204:207]
    ds_read_b64_tr_b16 v[48:49], v24 offset:16384
    ds_read_b64_tr_b16 v[50:51], v24 offset:17408
    v_mfma_f32_16x16x32_bf16 v[208:211], v[52:55], v[88:91], v[208:211]
    v_mov_b32 v42, 81920
    v_mfma_f32_16x16x32_bf16 v[212:215], v[52:55], v[92:95], v[212:215]
    buffer_load_dwordx4 v11, s[52:55], s34 offen offset:1024  lds
    v_mfma_f32_16x16x32_bf16 v[216:219], v[52:55], v[96:99], v[216:219]
    ds_read_b32 v47, v42
    v_mfma_f32_16x16x32_bf16 v[220:223], v[52:55], v[100:103], v[220:223]
    ds_read_b64_tr_b16 v[52:53], v25 offset:16384
    ds_read_b64_tr_b16 v[54:55], v25 offset:17408
    v_mfma_f32_16x16x32_bf16 v[224:227], v[56:59], v[88:91], v[224:227]
    v_mfma_f32_16x16x32_bf16 v[228:231], v[56:59], v[92:95], v[228:231]
    buffer_load_dwordx4 v12, s[52:55], s34 offen offset:2048  lds
    v_mfma_f32_16x16x32_bf16 v[232:235], v[56:59], v[96:99], v[232:235]
    v_mfma_f32_16x16x32_bf16 v[236:239], v[56:59], v[100:103], v[236:239]
    v_mfma_f32_16x16x32_bf16 v[240:243], v[60:63], v[88:91], v[240:243]
    v_mfma_f32_16x16x32_bf16 v[244:247], v[60:63], v[92:95], v[244:247]
    buffer_load_dwordx4 v13, s[52:55], s34 offen offset:3072  lds
    v_mfma_f32_16x16x32_bf16 v[248:251], v[60:63], v[96:99], v[248:251]
    v_mfma_f32_16x16x32_bf16 v[252:255], v[60:63], v[100:103], v[252:255]
    s_waitcnt vmcnt(63) lgkmcnt(0)
    s_barrier
    v_mfma_f32_16x16x32_bf16 v[128:131], v[64:67], v[104:107], v[128:131]
    s_add_u32 m0, s83, 0
    v_readfirstlane_b32 s93, v47
    v_mfma_f32_16x16x32_bf16 v[132:135], v[64:67], v[108:111], v[132:135]
    buffer_load_dwordx4 v14, s[48:51], s92 offen offset:0  lds
    s_xor_b32 s73, s83, 4096
    v_mfma_f32_16x16x32_bf16 v[136:139], v[64:67], v[112:115], v[136:139]
    s_add_u32 s73, s73, 81920
L_pad1:
    s_cbranch_execz L_warm0
    v_add_u32 v42, s73, v40
    v_mfma_f32_16x16x32_bf16 v[140:143], v[64:67], v[116:119], v[140:143]
    v_xor_b32 v43, 4096, v42
    v_add_u32 v18, 65536, v26
    v_mfma_f32_16x16x32_bf16 v[144:147], v[68:71], v[104:107], v[144:147]
    s_waitcnt vmcnt(13)
    ds_read_b64_tr_b16 a[0:1], v26 offset:32768
    v_mfma_f32_16x16x32_bf16 v[148:151], v[68:71], v[108:111], v[148:151]
    buffer_load_dwordx4 v15, s[48:51], s92 offen offset:1024  lds
    ds_read_b64_tr_b16 a[2:3], v26 offset:33792
    v_mfma_f32_16x16x32_bf16 v[152:155], v[68:71], v[112:115], v[152:155]
    ds_read_b64_tr_b16 a[4:5], v27 offset:32768
    ds_read_b64_tr_b16 a[6:7], v27 offset:33792
    v_mfma_f32_16x16x32_bf16 v[156:159], v[68:71], v[116:119], v[156:159]
    ds_read_b64_tr_b16 a[8:9], v28 offset:32768
    ds_read_b64_tr_b16 a[10:11], v28 offset:33792
    v_mfma_f32_16x16x32_bf16 v[160:163], v[72:75], v[104:107], v[160:163]
    ds_read_b64_tr_b16 a[12:13], v29 offset:32768
    ds_read_b64_tr_b16 a[14:15], v29 offset:33792
    v_mfma_f32_16x16x32_bf16 v[164:167], v[72:75], v[108:111], v[164:167]
    buffer_load_dwordx4 v16, s[48:51], s92 offen offset:2048  lds
    ds_read_b64_tr_b16 a[16:17], v30 offset:32768
    v_mfma_f32_16x16x32_bf16 v[168:171], v[72:75], v[112:115], v[168:171]
    v_cvt_pk_bf16_f32 v128, v128, v129
    v_cvt_pk_bf16_f32 v129, v130, v131
    v_mfma_f32_16x16x32_bf16 v[172:175], v[72:75], v[116:119], v[172:175]
    v_cvt_pk_bf16_f32 v130, v144, v145
    v_cvt_pk_bf16_f32 v131, v146, v147
    v_mfma_f32_16x16x32_bf16 v[176:179], v[76:79], v[104:107], v[176:179]
    ds_read_b64_tr_b16 a[18:19], v30 offset:33792
    v_cvt_pk_bf16_f32 v132, v132, v133
    v_mfma_f32_16x16x32_bf16 v[180:183], v[76:79], v[108:111], v[180:183]
    buffer_load_dwordx4 v17, s[48:51], s92 offen offset:3072  lds
    s_add_u32 s92, s92, 14336
    v_mfma_f32_16x16x32_bf16 v[184:187], v[76:79], v[112:115], v[184:187]
    s_add_u32 m0, s83, 16384
    ds_read_b64_tr_b16 a[20:21], v31 offset:32768
    v_mfma_f32_16x16x32_bf16 v[188:191], v[76:79], v[116:119], v[188:191]
    v_cvt_pk_bf16_f32 v133, v134, v135
    ds_read_b64_tr_b16 a[22:23], v31 offset:33792
    v_mfma_f32_16x16x32_bf16 v[192:195], v[80:83], v[104:107], v[192:195]
    v_cvt_pk_bf16_f32 v134, v148, v149
    ds_read_b64_tr_b16 a[24:25], v32 offset:32768
    v_mfma_f32_16x16x32_bf16 v[196:199], v[80:83], v[108:111], v[196:199]
    buffer_load_dwordx4 v14, s[48:51], s92 offen offset:0  lds
    v_cvt_pk_bf16_f32 v135, v150, v151
    v_mfma_f32_16x16x32_bf16 v[200:203], v[80:83], v[112:115], v[200:203]
    ds_read_b64_tr_b16 a[26:27], v32 offset:33792
    v_cvt_pk_bf16_f32 v136, v136, v137
    v_mfma_f32_16x16x32_bf16 v[204:207], v[80:83], v[116:119], v[204:207]
    ds_read_b64_tr_b16 a[28:29], v33 offset:32768
    v_cvt_pk_bf16_f32 v137, v138, v139
    v_mfma_f32_16x16x32_bf16 v[208:211], v[84:87], v[104:107], v[208:211]
    ds_read_b64_tr_b16 a[30:31], v33 offset:33792
    v_cvt_pk_bf16_f32 v138, v152, v153
    v_mfma_f32_16x16x32_bf16 v[212:215], v[84:87], v[108:111], v[212:215]
    buffer_load_dwordx4 v15, s[48:51], s92 offen offset:1024  lds
    v_cvt_pk_bf16_f32 v139, v154, v155
    v_mfma_f32_16x16x32_bf16 v[216:219], v[84:87], v[112:115], v[216:219]
    v_cvt_pk_bf16_f32 v140, v140, v141
    v_cvt_pk_bf16_f32 v141, v142, v143
    v_mfma_f32_16x16x32_bf16 v[220:223], v[84:87], v[116:119], v[220:223]
    v_cvt_pk_bf16_f32 v142, v156, v157
    v_cvt_pk_bf16_f32 v143, v158, v159
    v_mfma_f32_16x16x32_bf16 v[224:227], v[48:51], v[104:107], v[224:227]
    v_cvt_pk_bf16_f32 v160, v160, v161
    v_cvt_pk_bf16_f32 v161, v162, v163
    v_mfma_f32_16x16x32_bf16 v[228:231], v[48:51], v[108:111], v[228:231]
    buffer_load_dwordx4 v16, s[48:51], s92 offen offset:2048  lds
    v_cvt_pk_bf16_f32 v162, v176, v177
    v_mfma_f32_16x16x32_bf16 v[232:235], v[48:51], v[112:115], v[232:235]
    v_cvt_pk_bf16_f32 v163, v178, v179
    v_cvt_pk_bf16_f32 v164, v164, v165
    v_mfma_f32_16x16x32_bf16 v[236:239], v[48:51], v[116:119], v[236:239]
    v_cvt_pk_bf16_f32 v165, v166, v167
    v_cvt_pk_bf16_f32 v166, v180, v181
    v_mfma_f32_16x16x32_bf16 v[240:243], v[52:55], v[104:107], v[240:243]
    v_cvt_pk_bf16_f32 v167, v182, v183
    v_cvt_pk_bf16_f32 v192, v192, v193
    v_mfma_f32_16x16x32_bf16 v[244:247], v[52:55], v[108:111], v[244:247]
    buffer_load_dwordx4 v17, s[48:51], s92 offen offset:3072  lds
    s_add_u32 s92, s92, 14336
    v_mfma_f32_16x16x32_bf16 v[248:251], v[52:55], v[112:115], v[248:251]
    s_add_u32 m0, s83, 147456
    s_add_u32 s34, s89, s84
    v_mfma_f32_16x16x32_bf16 v[252:255], v[52:55], v[116:119], v[252:255]
    v_cvt_pk_bf16_f32 v193, v194, v195
    v_cvt_pk_bf16_f32 v194, v208, v209
    v_mfma_f32_16x16x32_bf16 v[144:147], a[192:195], v[128:131], 0
    v_cvt_pk_bf16_f32 v195, v210, v211
    v_cvt_pk_bf16_f32 v196, v196, v197
    v_mfma_f32_16x16x32_bf16 v[148:151], a[192:195], v[132:135], 0
    buffer_load_dwordx4 v10, s[52:55], s34 offen offset:0  lds
    v_cvt_pk_bf16_f32 v197, v198, v199
    v_mfma_f32_16x16x32_bf16 v[152:155], a[208:211], v[128:131], 0
    v_cvt_pk_bf16_f32 v198, v212, v213
    v_cvt_pk_bf16_f32 v199, v214, v215
    v_mfma_f32_16x16x32_bf16 v[156:159], a[208:211], v[132:135], 0
    v_add_u32 v19, 65536, v27
    v_cvt_pk_bf16_f32 v224, v224, v225
    v_mfma_f32_16x16x32_bf16 v[144:147], a[196:199], v[160:163], v[144:147]
    v_add_u32 v20, 65536, v28
    v_cvt_pk_bf16_f32 v225, v226, v227
    v_mfma_f32_16x16x32_bf16 v[148:151], a[196:199], v[164:167], v[148:151]
    buffer_load_dwordx4 v11, s[52:55], s34 offen offset:1024  lds
    v_add_u32 v21, 65536, v29
    v_mfma_f32_16x16x32_bf16 v[152:155], a[212:215], v[160:163], v[152:155]
    v_cvt_pk_bf16_f32 v226, v240, v241
    v_add_u32 v22, 65536, v30
    v_mfma_f32_16x16x32_bf16 v[156:159], a[212:215], v[164:167], v[156:159]
    v_cvt_pk_bf16_f32 v227, v242, v243
    v_add_u32 v23, 65536, v31
    v_mfma_f32_16x16x32_bf16 v[144:147], a[200:203], v[192:195], v[144:147]
    v_add_u32 v24, 65536, v32
    v_add_u32 v25, 65536, v33
    v_mfma_f32_16x16x32_bf16 v[148:151], a[200:203], v[196:199], v[148:151]
    v_cvt_pk_bf16_f32 v228, v228, v229
    v_cvt_pk_bf16_f32 v229, v230, v231
    v_cvt_pk_bf16_f32 v230, v244, v245
    v_cvt_pk_bf16_f32 v231, v246, v247
    v_mfma_f32_16x16x32_bf16 v[152:155], a[216:219], v[192:195], v[152:155]
    buffer_load_dwordx4 v12, s[52:55], s34 offen offset:2048  lds
    v_cvt_pk_bf16_f32 v168, v168, v169
    v_mfma_f32_16x16x32_bf16 v[156:159], a[216:219], v[196:199], v[156:159]
    v_cvt_pk_bf16_f32 v169, v170, v171
    v_cvt_pk_bf16_f32 v170, v184, v185
    v_mfma_f32_16x16x32_bf16 v[144:147], a[204:207], v[224:227], v[144:147]
    v_cvt_pk_bf16_f32 v171, v186, v187
    v_cvt_pk_bf16_f32 v172, v172, v173
    v_mfma_f32_16x16x32_bf16 v[148:151], a[204:207], v[228:231], v[148:151]
    v_cvt_pk_bf16_f32 v173, v174, v175
    v_cvt_pk_bf16_f32 v174, v188, v189
    v_cvt_pk_bf16_f32 v175, v190, v191
    v_cvt_pk_bf16_f32 v200, v200, v201
    v_cvt_pk_bf16_f32 v201, v202, v203
    v_cvt_pk_bf16_f32 v202, v216, v217
    v_cvt_pk_bf16_f32 v203, v218, v219
    v_cvt_pk_bf16_f32 v204, v204, v205
    v_cvt_pk_bf16_f32 v205, v206, v207
    v_cvt_pk_bf16_f32 v206, v220, v221
    v_cvt_pk_bf16_f32 v207, v222, v223
    v_mfma_f32_16x16x32_bf16 v[152:155], a[220:223], v[224:227], v[152:155]
    buffer_load_dwordx4 v13, s[52:55], s34 offen offset:3072  lds
    s_waitcnt vmcnt(16)
    v_mfma_f32_16x16x32_bf16 v[156:159], a[220:223], v[228:231], v[156:159]
    s_add_u32 m0, s83, 65536
    s_add_u32 s34, s88, s85
    v_mfma_f32_16x16x32_bf16 v[88:91], a[224:227], v[136:139], 0
    ds_read_b64_tr_b16 a[32:33], v120 offset:0
    ds_read_b64_tr_b16 a[34:35], v120 offset:1024
    v_mfma_f32_16x16x32_bf16 v[92:95], a[224:227], v[140:143], 0
    ds_read_b64_tr_b16 a[36:37], v121 offset:0
    ds_read_b64_tr_b16 a[38:39], v121 offset:1024
    v_mfma_f32_16x16x32_bf16 v[96:99], a[240:243], v[136:139], 0
    v_add_u32 v34, 65536, v38
    v_add_u32 v35, 65536, v39
    v_add_u32 v36, 131072, v38
    v_add_u32 v37, 131072, v39
    v_mfma_f32_16x16x32_bf16 v[100:103], a[240:243], v[140:143], 0
    buffer_load_dwordx4 v10, s[52:55], s34 offen offset:0  lds
    ds_read_b64_tr_b16 a[40:41], v122 offset:0
    v_mfma_f32_16x16x32_bf16 v[88:91], a[228:231], v[168:171], v[88:91]
    ds_read_b64_tr_b16 a[42:43], v122 offset:1024
    ds_read_b64_tr_b16 a[44:45], v123 offset:0
    v_mfma_f32_16x16x32_bf16 v[92:95], a[228:231], v[172:175], v[92:95]
    ds_read_b64_tr_b16 a[46:47], v123 offset:1024
    ds_read_b64_tr_b16 a[48:49], v124 offset:0
    v_mfma_f32_16x16x32_bf16 v[96:99], a[244:247], v[168:171], v[96:99]
    ds_read_b64_tr_b16 a[50:51], v124 offset:1024
    ds_read_b64_tr_b16 a[52:53], v125 offset:0
    ds_read_b64_tr_b16 a[54:55], v125 offset:1024
    ds_read_b64_tr_b16 a[56:57], v126 offset:0
    ds_read_b64_tr_b16 a[58:59], v126 offset:1024
    ds_read_b64_tr_b16 a[60:61], v127 offset:0
    ds_read_b64_tr_b16 a[62:63], v127 offset:1024
    v_mfma_f32_16x16x32_bf16 v[100:103], a[244:247], v[172:175], v[100:103]
    buffer_load_dwordx4 v11, s[52:55], s34 offen offset:1024  lds
    v_cvt_pk_bf16_f32 v232, v232, v233
    v_mfma_f32_16x16x32_bf16 v[88:91], a[232:235], v[200:203], v[88:91]
    v_cvt_pk_bf16_f32 v233, v234, v235
    v_cvt_pk_bf16_f32 v234, v248, v249
    v_mfma_f32_16x16x32_bf16 v[92:95], a[232:235], v[204:207], v[92:95]
    v_cvt_pk_bf16_f32 v235, v250, v251
    v_cvt_pk_bf16_f32 v236, v236, v237
    v_cvt_pk_bf16_f32 v237, v238, v239
    v_cvt_pk_bf16_f32 v238, v252, v253
    v_cvt_pk_bf16_f32 v239, v254, v255
    v_mfma_f32_16x16x32_bf16 v[96:99], a[248:251], v[200:203], v[96:99]
    ds_write_b128 v42, v[144:147] offset:0
    buffer_load_dwordx4 v12, s[52:55], s34 offen offset:2048  lds
    v_mfma_f32_16x16x32_bf16 v[100:103], a[248:251], v[204:207], v[100:103]
    ds_write_b128 v42, v[148:151] offset:1024
    v_mfma_f32_16x16x32_bf16 v[88:91], a[236:239], v[232:235], v[88:91]
    v_mfma_f32_16x16x32_bf16 v[92:95], a[236:239], v[236:239], v[92:95]
    ds_write_b128 v42, v[152:155] offset:2048
    v_mfma_f32_16x16x32_bf16 v[96:99], a[252:255], v[232:235], v[96:99]
    v_mfma_f32_16x16x32_bf16 v[100:103], a[252:255], v[236:239], v[100:103]
    buffer_load_dwordx4 v13, s[52:55], s34 offen offset:3072  lds
    ds_write_b128 v42, v[156:159] offset:3072
    s_waitcnt lgkmcnt(0)
    s_barrier
    ds_read_b128 v[104:107], v43 offset:0
    ds_read_b128 v[108:111], v43 offset:1024
    ds_read_b128 v[112:115], v43 offset:2048
    ds_read_b128 v[116:119], v43 offset:3072
    s_waitcnt vmcnt(16)
    ds_read_b128 v[48:51], v36 offset:0
    ds_read_b128 v[52:55], v36 offset:2048
    ds_read_b128 v[56:59], v37 offset:0
    ds_read_b128 v[60:63], v37 offset:2048
    s_waitcnt lgkmcnt(2)
    v_mfma_f32_16x16x32_bf16 v[128:131], v[48:51], a[0:3], 0
    s_add_u32 m0, s83, 32768
    s_waitcnt lgkmcnt(4)
    s_and_b32 s73, s93, 1
    s_lshl_b32 s73, s73, 15
    v_mfma_f32_16x16x32_bf16 v[136:139], v[48:51], a[4:7], 0
    buffer_load_dwordx4 v14, s[48:51], s92 offen offset:0  lds
    v_mov_b32 v47, s73
    v_xor_b32 v46, 0x8000, v47
    v_add_f32 v88, v88, v104
    v_mfma_f32_16x16x32_bf16 v[144:147], v[48:51], a[8:11], 0
    v_add_f32 v89, v89, v105
    v_add_f32 v90, v90, v106
    v_add_f32 v91, v91, v107
    v_add_f32 v92, v92, v108
    v_mfma_f32_16x16x32_bf16 v[152:155], v[48:51], a[12:15], 0
    buffer_load_dwordx4 v15, s[48:51], s92 offen offset:1024  lds
    v_add_f32 v93, v93, v109
    v_add_f32 v94, v94, v110
    v_add_f32 v95, v95, v111
    v_mfma_f32_16x16x32_bf16 v[160:163], v[48:51], a[16:19], 0
    v_add_f32 v96, v96, v112
    v_add_f32 v97, v97, v113
    v_add_f32 v98, v98, v114
    v_add_f32 v99, v99, v115
    v_mfma_f32_16x16x32_bf16 v[168:171], v[48:51], a[20:23], 0
    buffer_load_dwordx4 v16, s[48:51], s92 offen offset:2048  lds
    v_add_f32 v100, v100, v116
    v_add_f32 v101, v101, v117
    v_add_f32 v102, v102, v118
    v_mfma_f32_16x16x32_bf16 v[176:179], v[48:51], a[24:27], 0
    v_add_f32 v103, v103, v119
    v_max3_f32 v104, v88, v89, v90
    v_max3_f32 v105, v92, v93, v94
    v_max3_f32 v104, v104, v91, v96
    v_mfma_f32_16x16x32_bf16 v[184:187], v[48:51], a[28:31], 0
    buffer_load_dwordx4 v17, s[48:51], s92 offen offset:3072  lds
    s_add_u32 s92, s92, 14336
    s_add_u32 m0, s83, 49152
    v_max3_f32 v105, v105, v95, v100
    v_mfma_f32_16x16x32_bf16 v[132:135], v[52:55], a[0:3], 0
    v_max3_f32 v104, v104, v97, v98
    v_max3_f32 v105, v105, v101, v102
    v_max_f32 v104, v104, v99
    v_max_f32 v105, v105, v103
    v_mfma_f32_16x16x32_bf16 v[140:143], v[52:55], a[4:7], 0
    buffer_load_dwordx4 v14, s[48:51], s92 offen offset:0  lds
    v_mov_b32 v106, v104
    v_mov_b32 v107, v105
    s_nop 0
    v_mfma_f32_16x16x32_bf16 v[148:151], v[52:55], a[8:11], 0
    v_permlane16_swap_b32 v104, v106
    v_permlane16_swap_b32 v105, v107
    v_max_f32 v104, v104, v106
    v_max_f32 v105, v105, v107
    v_mfma_f32_16x16x32_bf16 v[156:159], v[52:55], a[12:15], 0
    buffer_load_dwordx4 v15, s[48:51], s92 offen offset:1024  lds
    v_mov_b32 v106, v104
    v_mov_b32 v107, v105
    s_nop 0
    v_mfma_f32_16x16x32_bf16 v[164:167], v[52:55], a[16:19], 0
    v_permlane32_swap_b32 v104, v106
    v_permlane32_swap_b32 v105, v107
    v_max_f32 v104, v104, v106
    v_max_f32 v105, v105, v107
    v_mfma_f32_16x16x32_bf16 v[172:175], v[52:55], a[20:23], 0
    buffer_load_dwordx4 v16, s[48:51], s92 offen offset:2048  lds
    v_mul_f32 v104, s95, v104
    v_mul_f32 v105, s95, v105
    v_fma_f32 v88, v88, s95, -v104
    v_mfma_f32_16x16x32_bf16 v[180:183], v[52:55], a[24:27], 0
    v_fma_f32 v92, v92, s95, -v105
    v_fma_f32 v89, v89, s95, -v104
    v_fma_f32 v93, v93, s95, -v105
    v_fma_f32 v90, v90, s95, -v104
    v_mfma_f32_16x16x32_bf16 v[188:191], v[52:55], a[28:31], 0
    s_waitcnt lgkmcnt(0)
    buffer_load_dwordx4 v17, s[48:51], s92 offen offset:3072  lds
    s_add_u32 s92, s92, 14336
    s_cmp_eq_u32 s92, 229376
    s_cselect_b32 s92, 0, s92
    v_mfma_f32_16x16x32_bf16 v[128:131], v[56:59], a[32:35], v[128:131]
    s_add_u32 m0, s83, 114688
    s_add_u32 s34, s89, s85
    v_fma_f32 v94, v94, s95, -v105
    v_fma_f32 v91, v91, s95, -v104
    v_mfma_f32_16x16x32_bf16 v[136:139], v[56:59], a[36:39], v[136:139]
    buffer_load_dwordx4 v10, s[52:55], s34 offen offset:0  lds
    v_fma_f32 v95, v95, s95, -v105
    v_fma_f32 v96, v96, s95, -v104
    v_fma_f32 v100, v100, s95, -v105
    v_mfma_f32_16x16x32_bf16 v[144:147], v[56:59], a[40:43], v[144:147]
    v_fma_f32 v97, v97, s95, -v104
    v_fma_f32 v101, v101, s95, -v105
    v_fma_f32 v98, v98, s95, -v104
    v_fma_f32 v102, v102, s95, -v105
    v_mfma_f32_16x16x32_bf16 v[152:155], v[56:59], a[44:47], v[152:155]
    buffer_load_dwordx4 v11, s[52:55], s34 offen offset:1024  lds
    v_fma_f32 v99, v99, s95, -v104
    v_fma_f32 v103, v103, s95, -v105
    s_waitcnt vmcnt(18)
    v_mfma_f32_16x16x32_bf16 v[160:163], v[56:59], a[48:51], v[160:163]
    s_waitcnt vmcnt(14)
    ds_read_b128 v[64:67], v36 offset:16384
    ds_read_b128 v[68:71], v36 offset:18432
    ds_read_b64_tr_b16 a[64:65], v26 offset:0
    v_mfma_f32_16x16x32_bf16 v[168:171], v[56:59], a[52:55], v[168:171]
    buffer_load_dwordx4 v12, s[52:55], s34 offen offset:2048  lds
    v_exp_f32 v88, v88
    ds_read_b64_tr_b16 a[66:67], v26 offset:1024
    v_mfma_f32_16x16x32_bf16 v[176:179], v[56:59], a[56:59], v[176:179]
    v_exp_f32 v92, v92
    v_exp_f32 v89, v89
    v_mfma_f32_16x16x32_bf16 v[184:187], v[56:59], a[60:63], v[184:187]
    buffer_load_dwordx4 v13, s[52:55], s34 offen offset:3072  lds
    s_waitcnt lgkmcnt(8)
    s_add_u32 m0, s83, 81920
    ds_read_b64_tr_b16 a[68:69], v27 offset:0
    v_mfma_f32_16x16x32_bf16 v[132:135], v[60:63], a[32:35], v[132:135]
    v_exp_f32 v93, v93
    v_exp_f32 v90, v90
    v_mfma_f32_16x16x32_bf16 v[140:143], v[60:63], a[36:39], v[140:143]
    ds_read_b64_tr_b16 a[70:71], v27 offset:1024
    ds_read_b64_tr_b16 a[72:73], v28 offset:0
    ds_read_b64_tr_b16 a[74:75], v28 offset:1024
    ds_read_b64_tr_b16 a[76:77], v29 offset:0
    ds_read_b64_tr_b16 a[78:79], v29 offset:1024
    ds_read_b64_tr_b16 a[80:81], v30 offset:0
    ds_read_b64_tr_b16 a[82:83], v30 offset:1024
    ds_read_b64_tr_b16 a[84:85], v31 offset:0
    ds_read_b64_tr_b16 a[86:87], v31 offset:1024
    ds_read_b64_tr_b16 a[88:89], v32 offset:0
    ds_read_b64_tr_b16 a[90:91], v32 offset:1024
    ds_read_b64_tr_b16 a[92:93], v33 offset:0
    ds_read_b64_tr_b16 a[94:95], v33 offset:1024
    v_mfma_f32_16x16x32_bf16 v[148:151], v[60:63], a[40:43], v[148:151]
    buffer_load_dwordx4 v14, s[48:51], s92 offen offset:0  lds
    v_exp_f32 v94, v94
    s_waitcnt vmcnt(13)
    v_mfma_f32_16x16x32_bf16 v[156:159], v[60:63], a[44:47], v[156:159]
    v_exp_f32 v91, v91
    v_exp_f32 v95, v95
    v_mfma_f32_16x16x32_bf16 v[164:167], v[60:63], a[48:51], v[164:167]
    buffer_load_dwordx4 v15, s[48:51], s92 offen offset:1024  lds
    v_exp_f32 v96, v96
    ds_read_b128 v[48:51], v34 offset:0
    v_mfma_f32_16x16x32_bf16 v[172:175], v[60:63], a[52:55], v[172:175]
    v_exp_f32 v100, v100
    v_exp_f32 v97, v97
    v_mfma_f32_16x16x32_bf16 v[180:183], v[60:63], a[56:59], v[180:183]
    buffer_load_dwordx4 v16, s[48:51], s92 offen offset:2048  lds
    v_exp_f32 v101, v101
    ds_read_b128 v[52:55], v34 offset:2048
    v_mfma_f32_16x16x32_bf16 v[188:191], v[60:63], a[60:63], v[188:191]
    s_waitcnt lgkmcnt(15)
    v_exp_f32 v98, v98
    v_mfma_f32_16x16x32_bf16 v[192:195], v[64:67], a[0:3], 0
    v_exp_f32 v102, v102
    buffer_load_dwordx4 v17, s[48:51], s92 offen offset:3072  lds
    s_add_u32 s92, s92, 14336
    v_mfma_f32_16x16x32_bf16 v[200:203], v[64:67], a[4:7], 0
    s_add_u32 m0, s83, 98304
    v_exp_f32 v99, v99
    v_mfma_f32_16x16x32_bf16 v[208:211], v[64:67], a[8:11], 0
    v_exp_f32 v103, v103
    v_add_f32 v108, v88, v89
    buffer_load_dwordx4 v14, s[48:51], s92 offen offset:0  lds
    v_mfma_f32_16x16x32_bf16 v[216:219], v[64:67], a[12:15], 0
    v_add_f32 v109, v92, v93
    v_add_f32 v108, v108, v90
    v_add_f32 v109, v109, v94
    v_add_f32 v108, v108, v91
    v_mfma_f32_16x16x32_bf16 v[224:227], v[64:67], a[16:19], 0
    v_add_f32 v109, v109, v95
    v_add_f32 v108, v108, v96
    v_add_f32 v109, v109, v100
    buffer_load_dwordx4 v15, s[48:51], s92 offen offset:1024  lds
    v_mfma_f32_16x16x32_bf16 v[232:235], v[64:67], a[20:23], 0
    v_add_f32 v108, v108, v97
    v_add_f32 v109, v109, v101
    v_add_f32 v108, v108, v98
    v_add_f32 v109, v109, v102
    v_mfma_f32_16x16x32_bf16 v[240:243], v[64:67], a[24:27], 0
    v_add_f32 v108, v108, v99
    v_add_f32 v109, v109, v103
    v_mov_b32 v106, v108
    buffer_load_dwordx4 v16, s[48:51], s92 offen offset:2048  lds
    v_mfma_f32_16x16x32_bf16 v[248:251], v[64:67], a[28:31], 0
    v_mov_b32 v107, v109
    s_nop 0
    v_permlane16_swap_b32 v108, v106
    v_permlane16_swap_b32 v109, v107
    v_mfma_f32_16x16x32_bf16 v[196:199], v[68:71], a[0:3], 0
    v_add_f32 v108, v108, v106
    v_add_f32 v109, v109, v107
    v_mov_b32 v106, v108
    buffer_load_dwordx4 v17, s[48:51], s92 offen offset:3072  lds
    v_mfma_f32_16x16x32_bf16 v[204:207], v[68:71], a[4:7], 0
    s_add_u32 s92, s92, 14336
    s_add_u32 m0, s83, 131072
    s_add_u32 s34, s88, s86
    v_mov_b32 v107, v109
    v_mfma_f32_16x16x32_bf16 v[212:215], v[68:71], a[8:11], 0
    s_nop 0
    v_permlane32_swap_b32 v108, v106
    v_permlane32_swap_b32 v109, v107
    buffer_load_dwordx4 v10, s[52:55], s34 offen offset:0  lds
    v_mfma_f32_16x16x32_bf16 v[220:223], v[68:71], a[12:15], 0
    v_add_f32 v108, v108, v106
    v_add_f32 v109, v109, v107
    v_rcp_f32 v108, v108
    v_mfma_f32_16x16x32_bf16 v[228:231], v[68:71], a[16:19], 0
    v_rcp_f32 v109, v109
    s_nop 0
    buffer_load_dwordx4 v11, s[52:55], s34 offen offset:1024  lds
    v_mfma_f32_16x16x32_bf16 v[236:239], v[68:71], a[20:23], 0
    v_mul_f32 v88, v88, v108
    v_mul_f32 v92, v92, v109
    v_mul_f32 v89, v89, v108
    v_mul_f32 v93, v93, v109
    v_mul_f32 v90, v90, v108
    v_mul_f32 v94, v94, v109
    v_mul_f32 v91, v91, v108
    v_mul_f32 v95, v95, v109
    v_mul_f32 v96, v96, v108
    v_mul_f32 v100, v100, v109
    v_mul_f32 v97, v97, v108
    v_mul_f32 v101, v101, v109
    v_mul_f32 v98, v98, v108
    v_mul_f32 v102, v102, v109
    v_mul_f32 v99, v99, v108
    v_mul_f32 v103, v103, v109
    v_cvt_pk_bf16_f32 v112, v88, v89
    v_cvt_pk_bf16_f32 v113, v90, v91
    v_cvt_pk_bf16_f32 v114, v96, v97
    v_cvt_pk_bf16_f32 v115, v98, v99
    v_cvt_pk_bf16_f32 v116, v92, v93
    v_cvt_pk_bf16_f32 v117, v94, v95
    v_cvt_pk_bf16_f32 v118, v100, v101
    v_cvt_pk_bf16_f32 v119, v102, v103
    v_and_or_b32 v112, v112, s97, v47
    v_and_or_b32 v113, v113, s97, v47
    v_and_or_b32 v114, v114, s97, v46
    v_and_or_b32 v115, v115, s97, v46
    v_and_or_b32 v116, v116, s97, v47
    v_and_or_b32 v117, v117, s97, v46
    v_and_or_b32 v118, v118, s97, v46
    v_and_or_b32 v119, v119, s97, v47
    buffer_store_dwordx4 v[112:115], v0, s[56:59], s96 offen offset:0 sc1
    buffer_store_dwordx4 v[116:119], v0, s[56:59], s96 offen offset:2048 sc1
    v_mfma_f32_16x16x32_bf16 v[244:247], v[68:71], a[24:27], 0
    ds_read_b128 v[56:59], v37 offset:16384
    ds_read_b128 v[60:63], v37 offset:18432
    v_mfma_f32_16x16x32_bf16 v[252:255], v[68:71], a[28:31], 0
    s_waitcnt lgkmcnt(2)
    v_add_u32 v2, s83, v40
    v_mfma_f32_16x16x32_bf16 v[128:131], v[48:51], a[64:67], v[128:131]
    s_waitcnt vmcnt(16)
    ds_read_b64_tr_b16 a[96:97], v26 offset:32768
    v_mfma_f32_16x16x32_bf16 v[136:139], v[48:51], a[68:71], v[136:139]
    ds_read_b64_tr_b16 a[98:99], v26 offset:33792
    ds_read_b64_tr_b16 a[100:101], v27 offset:32768
    v_mfma_f32_16x16x32_bf16 v[144:147], v[48:51], a[72:75], v[144:147]
    ds_read_b64_tr_b16 a[102:103], v27 offset:33792
    ds_read_b64_tr_b16 a[104:105], v28 offset:32768
    v_mfma_f32_16x16x32_bf16 v[152:155], v[48:51], a[76:79], v[152:155]
    buffer_load_dwordx4 v12, s[52:55], s34 offen offset:2048  lds
    ds_read_b64_tr_b16 a[106:107], v28 offset:33792
    v_mfma_f32_16x16x32_bf16 v[160:163], v[48:51], a[80:83], v[160:163]
    ds_read_b64_tr_b16 a[108:109], v29 offset:32768
    s_lshr_b32 s73, s68, 1
    v_mfma_f32_16x16x32_bf16 v[168:171], v[48:51], a[84:87], v[168:171]
    ds_read_b64_tr_b16 a[110:111], v29 offset:33792
    s_add_u32 s79, s73, s70
    v_mfma_f32_16x16x32_bf16 v[176:179], v[48:51], a[88:91], v[176:179]
    buffer_load_dwordx4 v13, s[52:55], s34 offen offset:3072  lds
    s_waitcnt lgkmcnt(12)
    v_mfma_f32_16x16x32_bf16 v[184:187], v[48:51], a[92:95], v[184:187]
    s_add_u32 m0, s83, 0
    ds_read_b64_tr_b16 a[112:113], v30 offset:32768
    v_mfma_f32_16x16x32_bf16 v[132:135], v[52:55], a[64:67], v[132:135]
    s_lshl_b32 s73, s73, 14
    ds_read_b64_tr_b16 a[114:115], v30 offset:33792
    v_mfma_f32_16x16x32_bf16 v[140:143], v[52:55], a[68:71], v[140:143]
    ds_read_b64_tr_b16 a[116:117], v31 offset:32768
    ds_read_b64_tr_b16 a[118:119], v31 offset:33792
    ds_read_b64_tr_b16 a[120:121], v32 offset:32768
    ds_read_b64_tr_b16 a[122:123], v32 offset:33792
    ds_read_b64_tr_b16 a[124:125], v33 offset:32768
    ds_read_b64_tr_b16 a[126:127], v33 offset:33792
    v_mfma_f32_16x16x32_bf16 v[148:151], v[52:55], a[72:75], v[148:151]
    buffer_load_dwordx4 v14, s[48:51], s92 offen offset:0  lds
    s_and_b32 s74, s68, 1
    v_mfma_f32_16x16x32_bf16 v[156:159], v[52:55], a[76:79], v[156:159]
    s_lshl_b32 s74, s74, 11
    s_add_u32 s73, s73, s74
    v_mfma_f32_16x16x32_bf16 v[164:167], v[52:55], a[80:83], v[164:167]
    v_add_u32 v3, s73, v40
    v_add_u32 v4, 65536, v40
    v_mfma_f32_16x16x32_bf16 v[172:175], v[52:55], a[84:87], v[172:175]
    buffer_load_dwordx4 v15, s[48:51], s92 offen offset:1024  lds
    v_mov_b32 v6, s93
    v_mfma_f32_16x16x32_bf16 v[180:183], v[52:55], a[88:91], v[180:183]
    v_and_b32 v7, 15, v1
    v_mul_u32_u24 v8, 1792, v7
    v_mfma_f32_16x16x32_bf16 v[188:191], v[52:55], a[92:95], v[188:191]
    s_waitcnt lgkmcnt(15)
    v_add_u32 v5, 65536, v2
    v_mfma_f32_16x16x32_bf16 v[192:195], v[56:59], a[32:35], v[192:195]
    v_bfe_u32 v42, v1, 4, 1
    v_lshl_add_u32 v8, v42, 5, v8
    v_lshrrev_b32 v42, 5, v1
    v_lshl_add_u32 v8, v42, 4, v8
    v_sub_u32 v42, v41, v0
    v_add_u32 v8, v8, v42
    s_mov_b32 s78, 0xfffffffe
    s_cmp_eq_u32 s79, 4
    s_cselect_b32 s74, 0, 1
    v_and_b32 v9, s74, v6
    v_xor_b32 v45, s74, v9
    s_mov_b32 s81, 0x3f80
    s_mov_b32 s82, 0x3f800000
    v_mfma_f32_16x16x32_bf16 v[200:203], v[56:59], a[36:39], v[200:203]
    buffer_load_dwordx4 v16, s[48:51], s92 offen offset:2048  lds
    ds_read_b128 v[64:67], v35 offset:0
    v_mfma_f32_16x16x32_bf16 v[208:211], v[56:59], a[40:43], v[208:211]
    ds_read_b128 v[68:71], v35 offset:2048
    v_mfma_f32_16x16x32_bf16 v[216:219], v[56:59], a[44:47], v[216:219]
    v_mfma_f32_16x16x32_bf16 v[224:227], v[56:59], a[48:51], v[224:227]
    buffer_load_dwordx4 v17, s[48:51], s92 offen offset:3072  lds
    s_add_u32 s92, s92, 14336
    v_mfma_f32_16x16x32_bf16 v[232:235], v[56:59], a[52:55], v[232:235]
    s_add_u32 m0, s83, 16384
    s_waitcnt vmcnt(18)
    v_mfma_f32_16x16x32_bf16 v[240:243], v[56:59], a[56:59], v[240:243]
    ds_read_b128 v[48:51], v34 offset:49152
    ds_read_b128 v[52:55], v34 offset:51200
    v_mfma_f32_16x16x32_bf16 v[248:251], v[56:59], a[60:63], v[248:251]
    buffer_load_dwordx4 v14, s[48:51], s92 offen offset:0  lds
    v_mfma_f32_16x16x32_bf16 v[196:199], v[60:63], a[32:35], v[196:199]
    v_mfma_f32_16x16x32_bf16 v[204:207], v[60:63], a[36:39], v[204:207]
    v_mfma_f32_16x16x32_bf16 v[212:215], v[60:63], a[40:43], v[212:215]
    buffer_load_dwordx4 v15, s[48:51], s92 offen offset:1024  lds
    v_mfma_f32_16x16x32_bf16 v[220:223], v[60:63], a[44:47], v[220:223]
    v_mfma_f32_16x16x32_bf16 v[228:231], v[60:63], a[48:51], v[228:231]
    v_mfma_f32_16x16x32_bf16 v[236:239], v[60:63], a[52:55], v[236:239]
    buffer_load_dwordx4 v16, s[48:51], s92 offen offset:2048  lds
    v_mfma_f32_16x16x32_bf16 v[244:247], v[60:63], a[56:59], v[244:247]
    v_mfma_f32_16x16x32_bf16 v[252:255], v[60:63], a[60:63], v[252:255]
    s_waitcnt lgkmcnt(2)
    v_mfma_f32_16x16x32_bf16 v[128:131], v[64:67], a[96:99], v[128:131]
    buffer_load_dwordx4 v17, s[48:51], s92 offen offset:3072  lds
    s_waitcnt vmcnt(14)
    v_mfma_f32_16x16x32_bf16 v[136:139], v[64:67], a[100:103], v[136:139]
    s_add_u32 s92, s92, 14336
    s_cmp_eq_u32 s92, 229376
    s_cselect_b32 s92, 0, s92
    v_mfma_f32_16x16x32_bf16 v[144:147], v[64:67], a[104:107], v[144:147]
    s_waitcnt lgkmcnt(4)
    ds_read_b64_tr_b16 a[128:129], v18 offset:16384
    v_mfma_f32_16x16x32_bf16 v[152:155], v[64:67], a[108:111], v[152:155]
    s_add_u32 m0, s83, 49152
    s_add_u32 s34, s89, s86
    v_mfma_f32_16x16x32_bf16 v[160:163], v[64:67], a[112:115], v[160:163]
    buffer_load_dwordx4 v10, s[52:55], s34 offen offset:0  lds
    ds_read_b64_tr_b16 a[130:131], v18 offset:17408
    v_mfma_f32_16x16x32_bf16 v[168:171], v[64:67], a[116:119], v[168:171]
    ds_read_b64_tr_b16 a[132:133], v19 offset:16384
    ds_read_b64_tr_b16 a[134:135], v19 offset:17408
    v_mfma_f32_16x16x32_bf16 v[176:179], v[64:67], a[120:123], v[176:179]
    ds_read_b64_tr_b16 a[136:137], v20 offset:16384
    ds_read_b64_tr_b16 a[138:139], v20 offset:17408
    v_mfma_f32_16x16x32_bf16 v[184:187], v[64:67], a[124:127], v[184:187]
    buffer_load_dwordx4 v11, s[52:55], s34 offen offset:1024  lds
    ds_read_b64_tr_b16 a[140:141], v21 offset:16384
L_pad2:
    s_cbranch_execz L_warm0
    v_mfma_f32_16x16x32_bf16 v[132:135], v[68:71], a[96:99], v[132:135]
    ds_read_b64_tr_b16 a[142:143], v21 offset:17408
    ds_read_b64_tr_b16 a[144:145], v22 offset:16384
    v_mfma_f32_16x16x32_bf16 v[140:143], v[68:71], a[100:103], v[140:143]
    ds_read_b64_tr_b16 a[146:147], v22 offset:17408
    ds_read_b64_tr_b16 a[148:149], v23 offset:16384
    ds_read_b64_tr_b16 a[150:151], v23 offset:17408
    ds_read_b64_tr_b16 a[152:153], v24 offset:16384
    ds_read_b64_tr_b16 a[154:155], v24 offset:17408
    ds_read_b64_tr_b16 a[156:157], v25 offset:16384
    ds_read_b64_tr_b16 a[158:159], v25 offset:17408
    v_mfma_f32_16x16x32_bf16 v[148:151], v[68:71], a[104:107], v[148:151]
    buffer_load_dwordx4 v12, s[52:55], s34 offen offset:2048  lds
    s_waitcnt vmcnt(11)
    v_mfma_f32_16x16x32_bf16 v[156:159], v[68:71], a[108:111], v[156:159]
    ds_read_b128 v[56:59], v36 offset:0
    ds_read_b128 v[60:63], v36 offset:2048
    v_mfma_f32_16x16x32_bf16 v[164:167], v[68:71], a[112:115], v[164:167]
    v_mfma_f32_16x16x32_bf16 v[172:175], v[68:71], a[116:119], v[172:175]
    buffer_load_dwordx4 v13, s[52:55], s34 offen offset:3072  lds
    s_waitcnt lgkmcnt(2)
    v_mfma_f32_16x16x32_bf16 v[180:183], v[68:71], a[120:123], v[180:183]
    s_add_u32 m0, s83, 65536
    v_mfma_f32_16x16x32_bf16 v[188:191], v[68:71], a[124:127], v[188:191]
    s_waitcnt lgkmcnt(15)
    v_mfma_f32_16x16x32_bf16 v[192:195], v[48:51], a[64:67], v[192:195]
    buffer_load_dwordx4 v14, s[48:51], s92 offen offset:0  lds
    v_mfma_f32_16x16x32_bf16 v[200:203], v[48:51], a[68:71], v[200:203]
    v_mfma_f32_16x16x32_bf16 v[208:211], v[48:51], a[72:75], v[208:211]
    v_mfma_f32_16x16x32_bf16 v[216:219], v[48:51], a[76:79], v[216:219]
    buffer_load_dwordx4 v15, s[48:51], s92 offen offset:1024  lds
    v_mfma_f32_16x16x32_bf16 v[224:227], v[48:51], a[80:83], v[224:227]
    ds_read_b128 v[64:67], v35 offset:49152
    ds_read_b128 v[68:71], v35 offset:51200
    v_mfma_f32_16x16x32_bf16 v[232:235], v[48:51], a[84:87], v[232:235]
    v_mfma_f32_16x16x32_bf16 v[240:243], v[48:51], a[88:91], v[240:243]
    buffer_load_dwordx4 v16, s[48:51], s92 offen offset:2048  lds
    v_mfma_f32_16x16x32_bf16 v[248:251], v[48:51], a[92:95], v[248:251]
    v_mfma_f32_16x16x32_bf16 v[196:199], v[52:55], a[64:67], v[196:199]
    v_mfma_f32_16x16x32_bf16 v[204:207], v[52:55], a[68:71], v[204:207]
    buffer_load_dwordx4 v17, s[48:51], s92 offen offset:3072  lds
    s_add_u32 s92, s92, 14336
    v_mfma_f32_16x16x32_bf16 v[212:215], v[52:55], a[72:75], v[212:215]
    s_add_u32 m0, s83, 81920
    v_mfma_f32_16x16x32_bf16 v[220:223], v[52:55], a[76:79], v[220:223]
    v_mfma_f32_16x16x32_bf16 v[228:231], v[52:55], a[80:83], v[228:231]
    buffer_load_dwordx4 v14, s[48:51], s92 offen offset:0  lds
    v_mfma_f32_16x16x32_bf16 v[236:239], v[52:55], a[84:87], v[236:239]
    v_mfma_f32_16x16x32_bf16 v[244:247], v[52:55], a[88:91], v[244:247]
    v_mfma_f32_16x16x32_bf16 v[252:255], v[52:55], a[92:95], v[252:255]
    s_waitcnt lgkmcnt(2)
    buffer_load_dwordx4 v15, s[48:51], s92 offen offset:1024  lds
    v_mfma_f32_16x16x32_bf16 v[128:131], v[56:59], a[128:131], v[128:131]
    s_waitcnt vmcnt(10)
    ds_read_b64_tr_b16 a[160:161], v26 offset:0
    v_mfma_f32_16x16x32_bf16 v[136:139], v[56:59], a[132:135], v[136:139]
    ds_read_b64_tr_b16 a[162:163], v26 offset:1024
    ds_read_b64_tr_b16 a[164:165], v27 offset:0
    v_mfma_f32_16x16x32_bf16 v[144:147], v[56:59], a[136:139], v[144:147]
    ds_read_b64_tr_b16 a[166:167], v27 offset:1024
    buffer_load_dwordx4 v16, s[48:51], s92 offen offset:2048  lds
    v_mfma_f32_16x16x32_bf16 v[152:155], v[56:59], a[140:143], v[152:155]
    ds_read_b64_tr_b16 a[168:169], v28 offset:0
    ds_read_b64_tr_b16 a[170:171], v28 offset:1024
    v_mfma_f32_16x16x32_bf16 v[160:163], v[56:59], a[144:147], v[160:163]
    ds_read_b64_tr_b16 a[172:173], v29 offset:0
    ds_read_b64_tr_b16 a[174:175], v29 offset:1024
    v_mfma_f32_16x16x32_bf16 v[168:171], v[56:59], a[148:151], v[168:171]
    ds_read_b64_tr_b16 a[176:177], v30 offset:0
    buffer_load_dwordx4 v17, s[48:51], s92 offen offset:3072  lds
    v_mfma_f32_16x16x32_bf16 v[176:179], v[56:59], a[152:155], v[176:179]
    s_add_u32 s92, s92, 14336
    ds_read_b64_tr_b16 a[178:179], v30 offset:1024
    v_mfma_f32_16x16x32_bf16 v[184:187], v[56:59], a[156:159], v[184:187]
    s_add_u32 m0, s83, 147456
    s_add_u32 s34, s88, s87
    v_mfma_f32_16x16x32_bf16 v[132:135], v[60:63], a[128:131], v[132:135]
    ds_read_b64_tr_b16 a[180:181], v31 offset:0
    buffer_load_dwordx4 v10, s[52:55], s34 offen offset:0  lds
    v_mfma_f32_16x16x32_bf16 v[140:143], v[60:63], a[132:135], v[140:143]
    ds_read_b64_tr_b16 a[182:183], v31 offset:1024
    ds_read_b64_tr_b16 a[184:185], v32 offset:0
    ds_read_b64_tr_b16 a[186:187], v32 offset:1024
    ds_read_b64_tr_b16 a[188:189], v33 offset:0
    ds_read_b64_tr_b16 a[190:191], v33 offset:1024
    v_mfma_f32_16x16x32_bf16 v[148:151], v[60:63], a[136:139], v[148:151]
    ds_read_b128 v[48:51], v37 offset:0
    v_mfma_f32_16x16x32_bf16 v[156:159], v[60:63], a[140:143], v[156:159]
    buffer_load_dwordx4 v11, s[52:55], s34 offen offset:1024  lds
    ds_read_b128 v[52:55], v37 offset:2048
    v_mfma_f32_16x16x32_bf16 v[164:167], v[60:63], a[144:147], v[164:167]
    v_mfma_f32_16x16x32_bf16 v[172:175], v[60:63], a[148:151], v[172:175]
    v_mfma_f32_16x16x32_bf16 v[180:183], v[60:63], a[152:155], v[180:183]
    buffer_load_dwordx4 v12, s[52:55], s34 offen offset:2048  lds
    v_mfma_f32_16x16x32_bf16 v[188:191], v[60:63], a[156:159], v[188:191]
    s_waitcnt lgkmcnt(15)
    v_mfma_f32_16x16x32_bf16 v[192:195], v[64:67], a[96:99], v[192:195]
    v_mfma_f32_16x16x32_bf16 v[200:203], v[64:67], a[100:103], v[200:203]
    buffer_load_dwordx4 v13, s[52:55], s34 offen offset:3072  lds
    s_waitcnt lgkmcnt(2)
    v_mfma_f32_16x16x32_bf16 v[208:211], v[64:67], a[104:107], v[208:211]
    s_add_u32 m0, s83, 0
    v_mfma_f32_16x16x32_bf16 v[216:219], v[64:67], a[108:111], v[216:219]
    v_mfma_f32_16x16x32_bf16 v[224:227], v[64:67], a[112:115], v[224:227]
    buffer_load_dwordx4 v14, s[48:51], s92 offen offset:0  lds
    s_waitcnt vmcnt(13)
    v_mfma_f32_16x16x32_bf16 v[232:235], v[64:67], a[116:119], v[232:235]
    ds_read_b128 v[56:59], v38 offset:49152
    ds_read_b128 v[60:63], v38 offset:51200
    v_mfma_f32_16x16x32_bf16 v[240:243], v[64:67], a[120:123], v[240:243]
    v_mfma_f32_16x16x32_bf16 v[248:251], v[64:67], a[124:127], v[248:251]
    buffer_load_dwordx4 v15, s[48:51], s92 offen offset:1024  lds
    v_mfma_f32_16x16x32_bf16 v[196:199], v[68:71], a[96:99], v[196:199]
    v_mfma_f32_16x16x32_bf16 v[204:207], v[68:71], a[100:103], v[204:207]
    v_mfma_f32_16x16x32_bf16 v[212:215], v[68:71], a[104:107], v[212:215]
    buffer_load_dwordx4 v16, s[48:51], s92 offen offset:2048  lds
    v_mfma_f32_16x16x32_bf16 v[220:223], v[68:71], a[108:111], v[220:223]
    v_mfma_f32_16x16x32_bf16 v[228:231], v[68:71], a[112:115], v[228:231]
    v_mfma_f32_16x16x32_bf16 v[236:239], v[68:71], a[116:119], v[236:239]
    buffer_load_dwordx4 v17, s[48:51], s92 offen offset:3072  lds
    s_add_u32 s92, s92, 14336
    v_mfma_f32_16x16x32_bf16 v[244:247], v[68:71], a[120:123], v[244:247]
    s_add_u32 m0, s83, 16384
    v_mfma_f32_16x16x32_bf16 v[252:255], v[68:71], a[124:127], v[252:255]
    s_waitcnt lgkmcnt(2)
    v_mfma_f32_16x16x32_bf16 v[128:131], v[48:51], a[160:163], v[128:131]
    buffer_load_dwordx4 v14, s[48:51], s92 offen offset:0  lds
    s_waitcnt vmcnt(9)
    v_mfma_f32_16x16x32_bf16 v[136:139], v[48:51], a[164:167], v[136:139]
    ds_read_b64_tr_b16 a[192:193], v18 offset:0
    ds_read_b64_tr_b16 a[194:195], v18 offset:1024
    v_mfma_f32_16x16x32_bf16 v[144:147], v[48:51], a[168:171], v[144:147]
    ds_read_b64_tr_b16 a[196:197], v19 offset:0
    ds_read_b64_tr_b16 a[198:199], v19 offset:1024
    v_mfma_f32_16x16x32_bf16 v[152:155], v[48:51], a[172:175], v[152:155]
    buffer_load_dwordx4 v15, s[48:51], s92 offen offset:1024  lds
    ds_read_b64_tr_b16 a[200:201], v20 offset:0
    v_mfma_f32_16x16x32_bf16 v[160:163], v[48:51], a[176:179], v[160:163]
    ds_read_b64_tr_b16 a[202:203], v20 offset:1024
    ds_read_b64_tr_b16 a[204:205], v21 offset:0
    v_mfma_f32_16x16x32_bf16 v[168:171], v[48:51], a[180:183], v[168:171]
    ds_read_b64_tr_b16 a[206:207], v21 offset:1024
    ds_read_b64_tr_b16 a[208:209], v22 offset:0
    v_mfma_f32_16x16x32_bf16 v[176:179], v[48:51], a[184:187], v[176:179]
    buffer_load_dwordx4 v16, s[48:51], s92 offen offset:2048  lds
    ds_read_b64_tr_b16 a[210:211], v22 offset:1024
    v_mfma_f32_16x16x32_bf16 v[184:187], v[48:51], a[188:191], v[184:187]
    ds_read_b64_tr_b16 a[212:213], v23 offset:0
    ds_read_b64_tr_b16 a[214:215], v23 offset:1024
    v_mfma_f32_16x16x32_bf16 v[132:135], v[52:55], a[160:163], v[132:135]
    ds_read_b64_tr_b16 a[216:217], v24 offset:0
    ds_read_b64_tr_b16 a[218:219], v24 offset:1024
    v_mfma_f32_16x16x32_bf16 v[140:143], v[52:55], a[164:167], v[140:143]
    ds_read_b64_tr_b16 a[220:221], v25 offset:0
    ds_read_b64_tr_b16 a[222:223], v25 offset:1024
    v_mfma_f32_16x16x32_bf16 v[148:151], v[52:55], a[168:171], v[148:151]
    buffer_load_dwordx4 v17, s[48:51], s92 offen offset:3072  lds
    s_waitcnt vmcnt(8)
    v_mfma_f32_16x16x32_bf16 v[156:159], v[52:55], a[172:175], v[156:159]
    s_add_u32 s92, s92, 14336
    s_cmp_eq_u32 s92, 229376
    s_cselect_b32 s92, 0, s92
    v_mfma_f32_16x16x32_bf16 v[164:167], v[52:55], a[176:179], v[164:167]
    s_waitcnt lgkmcnt(15)
    ds_read_b128 v[64:67], v36 offset:16384
    v_mfma_f32_16x16x32_bf16 v[172:175], v[52:55], a[180:183], v[172:175]
    s_add_u32 m0, s83, 98304
    s_add_u32 s34, s89, s87
    v_mfma_f32_16x16x32_bf16 v[180:183], v[52:55], a[184:187], v[180:183]
    buffer_load_dwordx4 v10, s[52:55], s34 offen offset:0  lds
    ds_read_b128 v[68:71], v36 offset:18432
    v_mfma_f32_16x16x32_bf16 v[188:191], v[52:55], a[188:191], v[188:191]
    s_waitcnt lgkmcnt(15)
    v_mfma_f32_16x16x32_bf16 v[192:195], v[56:59], a[128:131], v[192:195]
    v_mfma_f32_16x16x32_bf16 v[200:203], v[56:59], a[132:135], v[200:203]
    buffer_load_dwordx4 v11, s[52:55], s34 offen offset:1024  lds
    v_mfma_f32_16x16x32_bf16 v[208:211], v[56:59], a[136:139], v[208:211]
    v_mfma_f32_16x16x32_bf16 v[216:219], v[56:59], a[140:143], v[216:219]
    v_mfma_f32_16x16x32_bf16 v[224:227], v[56:59], a[144:147], v[224:227]
    buffer_load_dwordx4 v12, s[52:55], s34 offen offset:2048  lds
    ds_read_b128 v[48:51], v39 offset:49152
    v_mfma_f32_16x16x32_bf16 v[232:235], v[56:59], a[148:151], v[232:235]
    ds_read_b128 v[52:55], v39 offset:51200
    v_mfma_f32_16x16x32_bf16 v[240:243], v[56:59], a[152:155], v[240:243]
    v_mfma_f32_16x16x32_bf16 v[248:251], v[56:59], a[156:159], v[248:251]
    buffer_load_dwordx4 v13, s[52:55], s34 offen offset:3072  lds
    v_mfma_f32_16x16x32_bf16 v[196:199], v[60:63], a[128:131], v[196:199]
    s_add_u32 m0, s83, 114688
    s_add_u32 s34, s90, s84
    v_mfma_f32_16x16x32_bf16 v[204:207], v[60:63], a[132:135], v[204:207]
    v_mfma_f32_16x16x32_bf16 v[212:215], v[60:63], a[136:139], v[212:215]
    buffer_load_dwordx4 v10, s[52:55], s34 offen offset:0  lds
    v_mfma_f32_16x16x32_bf16 v[220:223], v[60:63], a[140:143], v[220:223]
    v_mfma_f32_16x16x32_bf16 v[228:231], v[60:63], a[144:147], v[228:231]
    v_mfma_f32_16x16x32_bf16 v[236:239], v[60:63], a[148:151], v[236:239]
    buffer_load_dwordx4 v11, s[52:55], s34 offen offset:1024  lds
    v_mfma_f32_16x16x32_bf16 v[244:247], v[60:63], a[152:155], v[244:247]
    v_mfma_f32_16x16x32_bf16 v[252:255], v[60:63], a[156:159], v[252:255]
    s_waitcnt lgkmcnt(2)
    v_mfma_f32_16x16x32_bf16 v[128:131], v[64:67], a[192:195], v[128:131]
    buffer_load_dwordx4 v12, s[52:55], s34 offen offset:2048  lds
    s_waitcnt vmcnt(7)
    v_mfma_f32_16x16x32_bf16 v[136:139], v[64:67], a[196:199], v[136:139]
    ds_read_b64_tr_b16 a[224:225], v26 offset:0
    ds_read_b64_tr_b16 a[226:227], v26 offset:1024
    v_mfma_f32_16x16x32_bf16 v[144:147], v[64:67], a[200:203], v[144:147]
    ds_read_b64_tr_b16 a[228:229], v27 offset:0
    ds_read_b64_tr_b16 a[230:231], v27 offset:1024
    v_mfma_f32_16x16x32_bf16 v[152:155], v[64:67], a[204:207], v[152:155]
    buffer_load_dwordx4 v13, s[52:55], s34 offen offset:3072  lds
    ds_read_b64_tr_b16 a[232:233], v28 offset:0
    v_mfma_f32_16x16x32_bf16 v[160:163], v[64:67], a[208:211], v[160:163]
    s_add_u32 m0, s83, 131072
    s_add_u32 s34, s90, s85
    v_mfma_f32_16x16x32_bf16 v[168:171], v[64:67], a[212:215], v[168:171]
    ds_read_b64_tr_b16 a[234:235], v28 offset:1024
    ds_read_b64_tr_b16 a[236:237], v29 offset:0
    v_mfma_f32_16x16x32_bf16 v[176:179], v[64:67], a[216:219], v[176:179]
    buffer_load_dwordx4 v10, s[52:55], s34 offen offset:0  lds
    ds_read_b64_tr_b16 a[238:239], v29 offset:1024
    v_mfma_f32_16x16x32_bf16 v[184:187], v[64:67], a[220:223], v[184:187]
    ds_read_b64_tr_b16 a[240:241], v30 offset:0
    ds_read_b64_tr_b16 a[242:243], v30 offset:1024
    v_mfma_f32_16x16x32_bf16 v[132:135], v[68:71], a[192:195], v[132:135]
    ds_read_b64_tr_b16 a[244:245], v31 offset:0
    ds_read_b64_tr_b16 a[246:247], v31 offset:1024
    v_mfma_f32_16x16x32_bf16 v[140:143], v[68:71], a[196:199], v[140:143]
    ds_read_b64_tr_b16 a[248:249], v32 offset:0
    ds_read_b64_tr_b16 a[250:251], v32 offset:1024
    ds_read_b64_tr_b16 a[252:253], v33 offset:0
    ds_read_b64_tr_b16 a[254:255], v33 offset:1024
    v_mfma_f32_16x16x32_bf16 v[148:151], v[68:71], a[200:203], v[148:151]
    buffer_load_dwordx4 v11, s[52:55], s34 offen offset:1024  lds
    ds_read_b128 v[56:59], v37 offset:16384
    v_mfma_f32_16x16x32_bf16 v[156:159], v[68:71], a[204:207], v[156:159]
    ds_read_b128 v[60:63], v37 offset:18432
    v_mfma_f32_16x16x32_bf16 v[164:167], v[68:71], a[208:211], v[164:167]
    v_mfma_f32_16x16x32_bf16 v[172:175], v[68:71], a[212:215], v[172:175]
    buffer_load_dwordx4 v12, s[52:55], s34 offen offset:2048  lds
    v_mfma_f32_16x16x32_bf16 v[180:183], v[68:71], a[216:219], v[180:183]
    v_mfma_f32_16x16x32_bf16 v[188:191], v[68:71], a[220:223], v[188:191]
    s_waitcnt lgkmcnt(15)
    v_mfma_f32_16x16x32_bf16 v[192:195], v[48:51], a[160:163], v[192:195]
    buffer_load_dwordx4 v13, s[52:55], s34 offen offset:3072  lds
    s_add_u32 s73, s71, s68
    v_mfma_f32_16x16x32_bf16 v[200:203], v[48:51], a[164:167], v[200:203]
    s_add_u32 s73, s73, 1
    s_and_b32 s73, s73, 3
    v_mfma_f32_16x16x32_bf16 v[208:211], v[48:51], a[168:171], v[208:211]
    s_lshl_b32 s73, s73, 14
    s_lshr_b32 s74, s101, 2
    v_mfma_f32_16x16x32_bf16 v[216:219], v[48:51], a[172:175], v[216:219]
    s_lshl_b32 s74, s74, 16
    s_add_u32 s73, s73, s74
    v_mfma_f32_16x16x32_bf16 v[224:227], v[48:51], a[176:179], v[224:227]
    s_add_u32 s96, s73, 1048576
    s_add_u32 s77, s96, 4096
    v_mfma_f32_16x16x32_bf16 v[232:235], v[48:51], a[180:183], v[232:235]
    s_add_u32 s80, s96, 8192
    s_add_u32 s94, s96, 12288
    v_mfma_f32_16x16x32_bf16 v[240:243], v[48:51], a[184:187], v[240:243]
    buffer_load_dwordx4 v[88:91], v0, s[56:59], s96 offen offset:0 sc1
    s_waitcnt vmcnt(9)
    v_mfma_f32_16x16x32_bf16 v[248:251], v[48:51], a[188:191], v[248:251]
    ds_read_b128 v[64:67], v34 offset:32768
    ds_read_b128 v[68:71], v34 offset:34816
    v_mfma_f32_16x16x32_bf16 v[196:199], v[52:55], a[160:163], v[196:199]
    v_mfma_f32_16x16x32_bf16 v[204:207], v[52:55], a[164:167], v[204:207]
    buffer_load_dwordx4 v[92:95], v0, s[56:59], s96 offen offset:2048 sc1
    v_mfma_f32_16x16x32_bf16 v[212:215], v[52:55], a[168:171], v[212:215]
    v_mfma_f32_16x16x32_bf16 v[220:223], v[52:55], a[172:175], v[220:223]
    v_mfma_f32_16x16x32_bf16 v[228:231], v[52:55], a[176:179], v[228:231]
    buffer_load_dwordx4 v[96:99], v0, s[56:59], s77 offen offset:0 sc1
    v_mfma_f32_16x16x32_bf16 v[236:239], v[52:55], a[180:183], v[236:239]
    v_mfma_f32_16x16x32_bf16 v[244:247], v[52:55], a[184:187], v[244:247]
    v_mfma_f32_16x16x32_bf16 v[252:255], v[52:55], a[188:191], v[252:255]
    s_waitcnt lgkmcnt(2)
    buffer_load_dwordx4 v[100:103], v0, s[56:59], s77 offen offset:2048 sc1
    v_mfma_f32_16x16x32_bf16 v[128:131], v[56:59], a[224:227], v[128:131]
    v_mfma_f32_16x16x32_bf16 v[132:135], v[60:63], a[224:227], v[132:135]
    v_mfma_f32_16x16x32_bf16 v[136:139], v[56:59], a[228:231], v[136:139]
    v_mfma_f32_16x16x32_bf16 v[140:143], v[60:63], a[228:231], v[140:143]
    v_mfma_f32_16x16x32_bf16 v[144:147], v[56:59], a[232:235], v[144:147]
    buffer_load_dwordx4 v[104:107], v0, s[56:59], s80 offen offset:0 sc1
    ds_read_b128 v[48:51], v35 offset:32768
    v_mfma_f32_16x16x32_bf16 v[148:151], v[60:63], a[232:235], v[148:151]
    ds_read_b128 v[52:55], v35 offset:34816
    v_mfma_f32_16x16x32_bf16 v[152:155], v[56:59], a[236:239], v[152:155]
    v_mfma_f32_16x16x32_bf16 v[156:159], v[60:63], a[236:239], v[156:159]
    v_mfma_f32_16x16x32_bf16 v[160:163], v[56:59], a[240:243], v[160:163]
    buffer_load_dwordx4 v[108:111], v0, s[56:59], s80 offen offset:2048 sc1
    v_cvt_pk_bf16_f32 v128, v128, v129
    v_mfma_f32_16x16x32_bf16 v[164:167], v[60:63], a[240:243], v[164:167]
    v_cvt_pk_bf16_f32 v129, v130, v131
    v_cvt_pk_bf16_f32 v130, v132, v133
    v_mfma_f32_16x16x32_bf16 v[168:171], v[56:59], a[244:247], v[168:171]
    v_cvt_pk_bf16_f32 v131, v134, v135
    ds_write_b128 v2, v[128:131] offset:0
    v_mfma_f32_16x16x32_bf16 v[172:175], v[60:63], a[244:247], v[172:175]
    v_cvt_pk_bf16_f32 v136, v136, v137
    v_cvt_pk_bf16_f32 v137, v138, v139
    v_mfma_f32_16x16x32_bf16 v[176:179], v[56:59], a[248:251], v[176:179]
    buffer_load_dwordx4 v[112:115], v0, s[56:59], s94 offen offset:0 sc1
    v_cvt_pk_bf16_f32 v138, v140, v141
    v_mfma_f32_16x16x32_bf16 v[180:183], v[60:63], a[248:251], v[180:183]
    v_cvt_pk_bf16_f32 v139, v142, v143
    ds_write_b128 v2, v[136:139] offset:1024
    v_mfma_f32_16x16x32_bf16 v[184:187], v[56:59], a[252:255], v[184:187]
    v_cvt_pk_bf16_f32 v144, v144, v145
    v_cvt_pk_bf16_f32 v145, v146, v147
    v_mfma_f32_16x16x32_bf16 v[188:191], v[60:63], a[252:255], v[188:191]
    s_waitcnt lgkmcnt(4)
    v_cvt_pk_bf16_f32 v146, v148, v149
    v_mfma_f32_16x16x32_bf16 v[192:195], v[64:67], a[192:195], v[192:195]
    buffer_load_dwordx4 v[116:119], v0, s[56:59], s94 offen offset:2048 sc1
    v_cvt_pk_bf16_f32 v147, v150, v151
    v_mfma_f32_16x16x32_bf16 v[196:199], v[68:71], a[192:195], v[196:199]
    s_waitcnt lgkmcnt(2)
    ds_write_b128 v2, v[144:147] offset:2048
    v_mfma_f32_16x16x32_bf16 v[192:195], v[48:51], a[224:227], v[192:195]
    s_add_u32 m0, s83, 147456
    s_add_u32 s34, s90, s86
    v_mfma_f32_16x16x32_bf16 v[196:199], v[52:55], a[224:227], v[196:199]
    v_cvt_pk_bf16_f32 v152, v152, v153
    v_cvt_pk_bf16_f32 v153, v154, v155
    v_mfma_f32_16x16x32_bf16 v[200:203], v[64:67], a[196:199], v[200:203]
    buffer_load_dwordx4 v10, s[52:55], s34 offen offset:0  lds
    s_waitcnt vmcnt(13)
    v_mfma_f32_16x16x32_bf16 v[204:207], v[68:71], a[196:199], v[204:207]
    ds_read_b128 v[56:59], v34 offset:49152
    ds_read_b128 v[60:63], v34 offset:51200
    v_mfma_f32_16x16x32_bf16 v[200:203], v[48:51], a[228:231], v[200:203]
    v_cvt_pk_bf16_f32 v154, v156, v157
    v_cvt_pk_bf16_f32 v155, v158, v159
    v_mfma_f32_16x16x32_bf16 v[204:207], v[52:55], a[228:231], v[204:207]
    ds_write_b128 v2, v[152:155] offset:3072
    v_cvt_pk_bf16_f32 v160, v160, v161
    v_mfma_f32_16x16x32_bf16 v[208:211], v[64:67], a[200:203], v[208:211]
    buffer_load_dwordx4 v11, s[52:55], s34 offen offset:1024  lds
    v_cvt_pk_bf16_f32 v161, v162, v163
    v_mfma_f32_16x16x32_bf16 v[212:215], v[68:71], a[200:203], v[212:215]
    v_cvt_pk_bf16_f32 v162, v164, v165
    v_cvt_pk_bf16_f32 v163, v166, v167
    v_mfma_f32_16x16x32_bf16 v[208:211], v[48:51], a[232:235], v[208:211]
    ds_write_b128 v2, v[160:163] offset:16384
    v_cvt_pk_bf16_f32 v168, v168, v169
    v_mfma_f32_16x16x32_bf16 v[212:215], v[52:55], a[232:235], v[212:215]
    v_cvt_pk_bf16_f32 v169, v170, v171
    v_cvt_pk_bf16_f32 v170, v172, v173
    v_mfma_f32_16x16x32_bf16 v[216:219], v[64:67], a[204:207], v[216:219]
    buffer_load_dwordx4 v12, s[52:55], s34 offen offset:2048  lds
    v_cvt_pk_bf16_f32 v171, v174, v175
    v_mfma_f32_16x16x32_bf16 v[220:223], v[68:71], a[204:207], v[220:223]
    ds_write_b128 v2, v[168:171] offset:17408
    v_cvt_pk_bf16_f32 v176, v176, v177
    v_mfma_f32_16x16x32_bf16 v[216:219], v[48:51], a[236:239], v[216:219]
    v_cvt_pk_bf16_f32 v177, v178, v179
    v_cvt_pk_bf16_f32 v178, v180, v181
    v_mfma_f32_16x16x32_bf16 v[220:223], v[52:55], a[236:239], v[220:223]
    v_cvt_pk_bf16_f32 v179, v182, v183
    ds_write_b128 v2, v[176:179] offset:18432
    v_mfma_f32_16x16x32_bf16 v[224:227], v[64:67], a[208:211], v[224:227]
    buffer_load_dwordx4 v13, s[52:55], s34 offen offset:3072  lds
    v_cvt_pk_bf16_f32 v184, v184, v185
    v_mfma_f32_16x16x32_bf16 v[228:231], v[68:71], a[208:211], v[228:231]
    s_add_u32 m0, s83, 98304
    s_add_u32 s34, s90, s87
    v_mfma_f32_16x16x32_bf16 v[224:227], v[48:51], a[240:243], v[224:227]
    v_cvt_pk_bf16_f32 v185, v186, v187
    v_cvt_pk_bf16_f32 v186, v188, v189
    v_mfma_f32_16x16x32_bf16 v[228:231], v[52:55], a[240:243], v[228:231]
    v_cvt_pk_bf16_f32 v187, v190, v191
    ds_write_b128 v2, v[184:187] offset:19456
    v_mfma_f32_16x16x32_bf16 v[232:235], v[64:67], a[212:215], v[232:235]
    buffer_load_dwordx4 v10, s[52:55], s34 offen offset:0  lds
    s_waitcnt vmcnt(5)
    v_mfma_f32_16x16x32_bf16 v[236:239], v[68:71], a[212:215], v[236:239]
    v_xor_b32 v88, v88, v47
    v_xor_b32 v89, v89, v47
    v_mfma_f32_16x16x32_bf16 v[232:235], v[48:51], a[244:247], v[232:235]
    v_xor_b32 v90, v90, v46
    v_xor_b32 v91, v91, v46
    v_mfma_f32_16x16x32_bf16 v[236:239], v[52:55], a[244:247], v[236:239]
    v_xor_b32 v92, v92, v47
    v_xor_b32 v93, v93, v46
    v_mfma_f32_16x16x32_bf16 v[240:243], v[64:67], a[216:219], v[240:243]
    buffer_load_dwordx4 v11, s[52:55], s34 offen offset:1024  lds
    v_xor_b32 v94, v94, v46
    v_mfma_f32_16x16x32_bf16 v[244:247], v[68:71], a[216:219], v[244:247]
    v_xor_b32 v95, v95, v47
    v_xor_b32 v96, v96, v47
    v_mfma_f32_16x16x32_bf16 v[240:243], v[48:51], a[248:251], v[240:243]
    v_xor_b32 v97, v97, v47
    v_xor_b32 v98, v98, v46
    v_mfma_f32_16x16x32_bf16 v[244:247], v[52:55], a[248:251], v[244:247]
    v_xor_b32 v99, v99, v46
    v_xor_b32 v100, v100, v47
    v_mfma_f32_16x16x32_bf16 v[248:251], v[64:67], a[220:223], v[248:251]
    buffer_load_dwordx4 v12, s[52:55], s34 offen offset:2048  lds
    v_xor_b32 v101, v101, v46
    v_mfma_f32_16x16x32_bf16 v[252:255], v[68:71], a[220:223], v[252:255]
    ds_read_b128 v[64:67], v35 offset:49152
    ds_read_b128 v[68:71], v35 offset:51200
    v_mfma_f32_16x16x32_bf16 v[248:251], v[48:51], a[252:255], v[248:251]
    v_xor_b32 v102, v102, v46
    v_xor_b32 v103, v103, v47
    v_mfma_f32_16x16x32_bf16 v[252:255], v[52:55], a[252:255], v[252:255]
    s_waitcnt lgkmcnt(7)
    v_xor_b32 v104, v104, v47
    v_mfma_f32_16x16x32_bf16 v[128:131], v[56:59], a[0:3], 0
    buffer_load_dwordx4 v13, s[52:55], s34 offen offset:3072  lds
    v_xor_b32 v105, v105, v47
    v_mfma_f32_16x16x32_bf16 v[136:139], v[56:59], a[4:7], 0
    v_xor_b32 v106, v106, v46
    v_xor_b32 v107, v107, v46
    v_mfma_f32_16x16x32_bf16 v[144:147], v[56:59], a[8:11], 0
    v_xor_b32 v108, v108, v47
    v_xor_b32 v109, v109, v46
    v_mfma_f32_16x16x32_bf16 v[152:155], v[56:59], a[12:15], 0
    v_xor_b32 v110, v110, v46
    v_xor_b32 v111, v111, v47
    v_mfma_f32_16x16x32_bf16 v[160:163], v[56:59], a[16:19], 0
    v_xor_b32 v112, v112, v47
    v_xor_b32 v113, v113, v47
    v_mfma_f32_16x16x32_bf16 v[168:171], v[56:59], a[20:23], 0
    v_xor_b32 v114, v114, v46
    v_xor_b32 v115, v115, v46
    v_mfma_f32_16x16x32_bf16 v[176:179], v[56:59], a[24:27], 0
    v_xor_b32 v116, v116, v47
    v_xor_b32 v117, v117, v46
    v_mfma_f32_16x16x32_bf16 v[184:187], v[56:59], a[28:31], 0
    v_xor_b32 v118, v118, v46
    v_xor_b32 v119, v119, v47
    v_mfma_f32_16x16x32_bf16 v[132:135], v[60:63], a[0:3], 0
    v_or_b32 v44, v88, v89
    v_or3_b32 v44, v90, v91, v44
    v_mfma_f32_16x16x32_bf16 v[140:143], v[60:63], a[4:7], 0
    v_or3_b32 v44, v92, v93, v44
    v_or3_b32 v44, v94, v95, v44
    v_mfma_f32_16x16x32_bf16 v[148:151], v[60:63], a[8:11], 0
    v_or3_b32 v44, v96, v97, v44
    v_or3_b32 v44, v98, v99, v44
    v_mfma_f32_16x16x32_bf16 v[156:159], v[60:63], a[12:15], 0
    v_or3_b32 v44, v100, v101, v44
    v_or3_b32 v44, v102, v103, v44
    v_mfma_f32_16x16x32_bf16 v[164:167], v[60:63], a[16:19], 0
    v_or3_b32 v44, v104, v105, v44
    v_or3_b32 v44, v106, v107, v44
    v_mfma_f32_16x16x32_bf16 v[172:175], v[60:63], a[20:23], 0
    v_or3_b32 v44, v108, v109, v44
    v_or3_b32 v44, v110, v111, v44
    v_mfma_f32_16x16x32_bf16 v[180:183], v[60:63], a[24:27], 0
    v_or3_b32 v44, v112, v113, v44
    v_or3_b32 v44, v114, v115, v44
    v_mfma_f32_16x16x32_bf16 v[188:191], v[60:63], a[28:31], 0
    s_waitcnt lgkmcnt(0)
    v_or3_b32 v44, v116, v117, v44
    v_mfma_f32_16x16x32_bf16 v[128:131], v[64:67], a[32:35], v[128:131]
    s_add_u32 m0, s83, 114688
    s_add_u32 s34, s91, s84
    v_mfma_f32_16x16x32_bf16 v[136:139], v[64:67], a[36:39], v[136:139]
    buffer_load_dwordx4 v10, s[52:55], s34 offen offset:0  lds
    v_or3_b32 v44, v118, v119, v44
    v_mfma_f32_16x16x32_bf16 v[144:147], v[64:67], a[40:43], v[144:147]
    v_and_b32 v44, 0x8000, v44
    v_cmp_ne_u32 vcc, 0, v44
    s_nop 1
    s_cmp_eq_u64 vcc, 0
    s_cbranch_scc0 L_slow1
L_ok1:
    v_mfma_f32_16x16x32_bf16 v[152:155], v[64:67], a[44:47], v[152:155]
    ds_write_b128 v5, v[88:91] offset:0
    s_waitcnt vmcnt(17)
    v_mfma_f32_16x16x32_bf16 v[160:163], v[64:67], a[48:51], v[160:163]
    ds_write_b128 v5, v[92:95] offset:1024
    ds_write_b128 v5, v[96:99] offset:2048
    ds_write_b128 v5, v[100:103] offset:3072
    ds_write_b128 v5, v[104:107] offset:16384
    ds_write_b128 v5, v[108:111] offset:17408
    ds_read_b128 v[48:51], v36 offset:0
    ds_write_b128 v5, v[112:115] offset:18432
    ds_read_b128 v[52:55], v36 offset:2048
    ds_write_b128 v5, v[116:119] offset:19456
    v_mfma_f32_16x16x32_bf16 v[168:171], v[64:67], a[52:55], v[168:171]
    buffer_load_dwordx4 v11, s[52:55], s34 offen offset:1024  lds
    v_cvt_pk_bf16_f32 v192, v192, v193
    v_mfma_f32_16x16x32_bf16 v[176:179], v[64:67], a[56:59], v[176:179]
    v_cvt_pk_bf16_f32 v193, v194, v195
    v_cvt_pk_bf16_f32 v194, v196, v197
    v_mfma_f32_16x16x32_bf16 v[184:187], v[64:67], a[60:63], v[184:187]
    s_waitcnt lgkmcnt(0)
    s_barrier
    v_mfma_f32_16x16x32_bf16 v[132:135], v[68:71], a[32:35], v[132:135]
    ds_read_b128 v[88:91], v3 offset:0
    v_cvt_pk_bf16_f32 v195, v198, v199
    v_mfma_f32_16x16x32_bf16 v[140:143], v[68:71], a[36:39], v[140:143]
    buffer_load_dwordx4 v12, s[52:55], s34 offen offset:2048  lds
    ds_read_b128 v[92:95], v3 offset:1024
    v_mfma_f32_16x16x32_bf16 v[148:151], v[68:71], a[40:43], v[148:151]
    ds_read_b128 v[96:99], v4 offset:0
    v_mfma_f32_16x16x32_bf16 v[156:159], v[68:71], a[44:47], v[156:159]
    ds_read_b128 v[100:103], v4 offset:1024
    v_mfma_f32_16x16x32_bf16 v[164:167], v[68:71], a[48:51], v[164:167]
    ds_read_b128 v[56:59], v37 offset:0
    v_mfma_f32_16x16x32_bf16 v[172:175], v[68:71], a[52:55], v[172:175]
    buffer_load_dwordx4 v13, s[52:55], s34 offen offset:3072  lds
    ds_read_b128 v[60:63], v37 offset:2048
    v_mfma_f32_16x16x32_bf16 v[180:183], v[68:71], a[56:59], v[180:183]
    ds_read_b128 v[104:107], v3 offset:4096
    v_mfma_f32_16x16x32_bf16 v[188:191], v[68:71], a[60:63], v[188:191]
    s_waitcnt lgkmcnt(8)
    ds_read_b128 v[108:111], v3 offset:5120
    v_mfma_f32_16x16x32_bf16 v[128:131], v[48:51], a[64:67], v[128:131]
    ds_read_b128 v[112:115], v4 offset:2048
    v_mfma_f32_16x16x32_bf16 v[136:139], v[48:51], a[68:71], v[136:139]
    ds_read_b128 v[116:119], v4 offset:3072
    v_mfma_f32_16x16x32_bf16 v[144:147], v[48:51], a[72:75], v[144:147]
    ds_write_b128 v2, v[192:195] offset:32768
    v_cvt_pk_bf16_f32 v200, v200, v201
    v_mfma_f32_16x16x32_bf16 v[152:155], v[48:51], a[76:79], v[152:155]
    s_waitcnt lgkmcnt(7)
    v_cvt_pk_bf16_f32 v201, v202, v203
    v_mfma_f32_16x16x32_bf16 v[72:75], v[88:91], v[96:99], 0
    s_waitcnt vmcnt(8)
    v_cvt_pk_bf16_f32 v202, v204, v205
    v_mfma_f32_16x16x32_bf16 v[76:79], v[88:91], v[100:103], 0
    ds_read_b128 v[64:67], v36 offset:16384
    v_cvt_pk_bf16_f32 v203, v206, v207
    v_mfma_f32_16x16x32_bf16 v[80:83], v[92:95], v[96:99], 0
    ds_read_b128 v[68:71], v36 offset:18432
    ds_write_b128 v2, v[200:203] offset:33792
    v_mfma_f32_16x16x32_bf16 v[84:87], v[92:95], v[100:103], 0
    v_cvt_pk_bf16_f32 v208, v208, v209
    v_cvt_pk_bf16_f32 v209, v210, v211
    v_mfma_f32_16x16x32_bf16 v[160:163], v[48:51], a[80:83], v[160:163]
    ds_read_b128 v[88:91], v3 offset:8192
    v_cvt_pk_bf16_f32 v210, v212, v213
    v_mfma_f32_16x16x32_bf16 v[168:171], v[48:51], a[84:87], v[168:171]
    ds_read_b128 v[92:95], v3 offset:9216
    v_cvt_pk_bf16_f32 v211, v214, v215
    v_mfma_f32_16x16x32_bf16 v[176:179], v[48:51], a[88:91], v[176:179]
    ds_read_b128 v[96:99], v4 offset:16384
    v_mfma_f32_16x16x32_bf16 v[184:187], v[48:51], a[92:95], v[184:187]
    s_waitcnt lgkmcnt(7)
    ds_read_b128 v[100:103], v4 offset:17408
    v_mfma_f32_16x16x32_bf16 v[72:75], v[104:107], v[112:115], v[72:75]
    ds_write_b128 v2, v[208:211] offset:34816
    v_cvt_pk_bf16_f32 v216, v216, v217
    v_mfma_f32_16x16x32_bf16 v[76:79], v[104:107], v[116:119], v[76:79]
    v_cvt_pk_bf16_f32 v217, v218, v219
    v_cvt_pk_bf16_f32 v218, v220, v221
    v_mfma_f32_16x16x32_bf16 v[80:83], v[108:111], v[112:115], v[80:83]
    v_cvt_pk_bf16_f32 v219, v222, v223
    ds_write_b128 v2, v[216:219] offset:35840
L_pad3:
    s_cbranch_execz L_warm0
    v_mfma_f32_16x16x32_bf16 v[84:87], v[108:111], v[116:119], v[84:87]
    v_cvt_pk_bf16_f32 v224, v224, v225
    v_cvt_pk_bf16_f32 v225, v226, v227
    v_mfma_f32_16x16x32_bf16 v[132:135], v[52:55], a[64:67], v[132:135]
    ds_read_b128 v[104:107], v3 offset:12288
    v_cvt_pk_bf16_f32 v226, v228, v229
    v_mfma_f32_16x16x32_bf16 v[140:143], v[52:55], a[68:71], v[140:143]
    ds_read_b128 v[108:111], v3 offset:13312
    v_cvt_pk_bf16_f32 v227, v230, v231
    v_mfma_f32_16x16x32_bf16 v[148:151], v[52:55], a[72:75], v[148:151]
    ds_read_b128 v[112:115], v4 offset:18432
    v_mfma_f32_16x16x32_bf16 v[156:159], v[52:55], a[76:79], v[156:159]
    s_waitcnt lgkmcnt(5)
    ds_read_b128 v[116:119], v4 offset:19456
    v_mfma_f32_16x16x32_bf16 v[72:75], v[88:91], v[96:99], v[72:75]
    ds_write_b128 v2, v[224:227] offset:49152
    v_cvt_pk_bf16_f32 v232, v232, v233
    v_mfma_f32_16x16x32_bf16 v[76:79], v[88:91], v[100:103], v[76:79]
    v_cvt_pk_bf16_f32 v233, v234, v235
    v_cvt_pk_bf16_f32 v234, v236, v237
    v_mfma_f32_16x16x32_bf16 v[80:83], v[92:95], v[96:99], v[80:83]
    v_cvt_pk_bf16_f32 v235, v238, v239
    ds_write_b128 v2, v[232:235] offset:50176
    v_mfma_f32_16x16x32_bf16 v[84:87], v[92:95], v[100:103], v[84:87]
    v_cvt_pk_bf16_f32 v240, v240, v241
    v_cvt_pk_bf16_f32 v241, v242, v243
    v_mfma_f32_16x16x32_bf16 v[164:167], v[52:55], a[80:83], v[164:167]
    v_cvt_pk_bf16_f32 v242, v244, v245
    v_cvt_pk_bf16_f32 v243, v246, v247
    v_mfma_f32_16x16x32_bf16 v[172:175], v[52:55], a[84:87], v[172:175]
    ds_write_b128 v2, v[240:243] offset:51200
    v_cvt_pk_bf16_f32 v248, v248, v249
    v_mfma_f32_16x16x32_bf16 v[180:183], v[52:55], a[88:91], v[180:183]
    v_cvt_pk_bf16_f32 v249, v250, v251
    v_cvt_pk_bf16_f32 v250, v252, v253
    v_mfma_f32_16x16x32_bf16 v[188:191], v[52:55], a[92:95], v[188:191]
    s_waitcnt lgkmcnt(3)
    v_cvt_pk_bf16_f32 v251, v254, v255
    v_mfma_f32_16x16x32_bf16 v[72:75], v[104:107], v[112:115], v[72:75]
    ds_write_b128 v2, v[248:251] offset:52224
    v_mfma_f32_16x16x32_bf16 v[76:79], v[104:107], v[116:119], v[76:79]
    v_mfma_f32_16x16x32_bf16 v[80:83], v[108:111], v[112:115], v[80:83]
    v_mfma_f32_16x16x32_bf16 v[84:87], v[108:111], v[116:119], v[84:87]
    s_waitcnt lgkmcnt(15)
    v_mfma_f32_16x16x32_bf16 v[128:131], v[56:59], a[96:99], v[128:131]
    s_add_u32 m0, s83, 131072
    s_add_u32 s34, s91, s85
    v_mfma_f32_16x16x32_bf16 v[136:139], v[56:59], a[100:103], v[136:139]
    buffer_load_dwordx4 v10, s[52:55], s34 offen offset:0  lds
    v_mfma_f32_16x16x32_bf16 v[144:147], v[56:59], a[104:107], v[144:147]
    v_mfma_f32_16x16x32_bf16 v[152:155], v[56:59], a[108:111], v[152:155]
    v_mfma_f32_16x16x32_bf16 v[160:163], v[56:59], a[112:115], v[160:163]
    ds_read_b128 v[48:51], v37 offset:16384
    ds_read_b128 v[52:55], v37 offset:18432
    v_mfma_f32_16x16x32_bf16 v[168:171], v[56:59], a[116:119], v[168:171]
    buffer_load_dwordx4 v11, s[52:55], s34 offen offset:1024  lds
    v_mfma_f32_16x16x32_bf16 v[176:179], v[56:59], a[120:123], v[176:179]
    v_add_u32 v72, 0x8000, v72
    v_add_u32 v74, 0x8000, v74
    v_mfma_f32_16x16x32_bf16 v[184:187], v[56:59], a[124:127], v[184:187]
    v_add_u32 v76, 0x8000, v76
    v_add_u32 v78, 0x8000, v78
    v_mfma_f32_16x16x32_bf16 v[132:135], v[60:63], a[96:99], v[132:135]
    v_add_u32 v80, 0x8000, v80
    v_add_u32 v82, 0x8000, v82
    v_mfma_f32_16x16x32_bf16 v[140:143], v[60:63], a[100:103], v[140:143]
    buffer_load_dwordx4 v12, s[52:55], s34 offen offset:2048  lds
    v_add_u32 v84, 0x8000, v84
    v_mfma_f32_16x16x32_bf16 v[148:151], v[60:63], a[104:107], v[148:151]
    v_add_u32 v86, 0x8000, v86
    v_cvt_pk_bf16_f32 v72, v72, v73
    v_mfma_f32_16x16x32_bf16 v[156:159], v[60:63], a[108:111], v[156:159]
    v_cvt_pk_bf16_f32 v73, v74, v75
    v_cvt_pk_bf16_f32 v74, v76, v77
    v_mfma_f32_16x16x32_bf16 v[164:167], v[60:63], a[112:115], v[164:167]
    v_cvt_pk_bf16_f32 v75, v78, v79
    v_cvt_pk_bf16_f32 v76, v80, v81
    v_mfma_f32_16x16x32_bf16 v[172:175], v[60:63], a[116:119], v[172:175]
    buffer_load_dwordx4 v13, s[52:55], s34 offen offset:3072  lds
    v_cvt_pk_bf16_f32 v77, v82, v83
    v_mfma_f32_16x16x32_bf16 v[180:183], v[60:63], a[120:123], v[180:183]
    v_cvt_pk_bf16_f32 v78, v84, v85
    v_cvt_pk_bf16_f32 v79, v86, v87
    v_mfma_f32_16x16x32_bf16 v[188:191], v[60:63], a[124:127], v[188:191]
    s_waitcnt lgkmcnt(15)
    v_and_or_b32 v72, v72, s78, v9
    v_mfma_f32_16x16x32_bf16 v[128:131], v[64:67], a[128:131], v[128:131]
    v_and_or_b32 v73, v73, s78, v9
    v_and_or_b32 v74, v74, s78, v45
    v_mfma_f32_16x16x32_bf16 v[136:139], v[64:67], a[132:135], v[136:139]
    v_and_or_b32 v75, v75, s78, v45
    v_and_or_b32 v76, v76, s78, v9
    v_mfma_f32_16x16x32_bf16 v[144:147], v[64:67], a[136:139], v[144:147]
    v_and_or_b32 v77, v77, s78, v45
    v_and_or_b32 v78, v78, s78, v45
    v_mfma_f32_16x16x32_bf16 v[152:155], v[64:67], a[140:143], v[152:155]
    v_and_or_b32 v79, v79, s78, v9
    v_mfma_f32_16x16x32_bf16 v[160:163], v[64:67], a[144:147], v[160:163]
    s_lshl_b32 s34, s98, 2
    s_add_u32 s34, s34, s68
    s_lshl_b32 s34, s34, 12
    s_add_u32 s34, s34, 8388608
    v_mfma_f32_16x16x32_bf16 v[168:171], v[64:67], a[148:151], v[168:171]
    buffer_store_dwordx4 v[72:75], v41, s[56:59], s34 offen offset:0 sc1
    s_waitcnt vmcnt(9)
    v_mfma_f32_16x16x32_bf16 v[176:179], v[64:67], a[152:155], v[176:179]
    ds_read_b128 v[56:59], v34 offset:32768
    ds_read_b128 v[60:63], v34 offset:34816
    v_mfma_f32_16x16x32_bf16 v[184:187], v[64:67], a[156:159], v[184:187]
    s_waitcnt lgkmcnt(4)
    s_barrier
    v_mfma_f32_16x16x32_bf16 v[132:135], v[68:71], a[128:131], v[132:135]
    ds_read_b128 v[192:195], v3 offset:32768
    ds_read_b128 v[196:199], v3 offset:33792
    v_mfma_f32_16x16x32_bf16 v[140:143], v[68:71], a[132:135], v[140:143]
    buffer_store_dwordx4 v[76:79], v41, s[56:59], s34 offen offset:2048 sc1
    ds_read_b128 v[200:203], v4 offset:4096
    v_mfma_f32_16x16x32_bf16 v[148:151], v[68:71], a[136:139], v[148:151]
    ds_read_b128 v[204:207], v4 offset:5120
    v_mfma_f32_16x16x32_bf16 v[156:159], v[68:71], a[140:143], v[156:159]
    ds_read_b128 v[208:211], v3 offset:36864
    v_mfma_f32_16x16x32_bf16 v[164:167], v[68:71], a[144:147], v[164:167]
    ds_read_b128 v[212:215], v3 offset:37888
    v_mfma_f32_16x16x32_bf16 v[172:175], v[68:71], a[148:151], v[172:175]
    ds_read_b128 v[216:219], v4 offset:6144
    v_mfma_f32_16x16x32_bf16 v[180:183], v[68:71], a[152:155], v[180:183]
    ds_read_b128 v[220:223], v4 offset:7168
    v_mfma_f32_16x16x32_bf16 v[188:191], v[68:71], a[156:159], v[188:191]
    s_waitcnt lgkmcnt(10)
    ds_read_b128 v[224:227], v3 offset:40960
    v_mfma_f32_16x16x32_bf16 v[128:131], v[48:51], a[160:163], v[128:131]
    s_add_u32 m0, s83, 147456
    s_add_u32 s34, s91, s86
    v_mfma_f32_16x16x32_bf16 v[136:139], v[48:51], a[164:167], v[136:139]
    buffer_load_dwordx4 v10, s[52:55], s34 offen offset:0  lds
    ds_read_b128 v[228:231], v3 offset:41984
    v_mfma_f32_16x16x32_bf16 v[144:147], v[48:51], a[168:171], v[144:147]
    ds_read_b128 v[232:235], v4 offset:20480
    ds_read_b128 v[236:239], v4 offset:21504
    v_mfma_f32_16x16x32_bf16 v[152:155], v[48:51], a[172:175], v[152:155]
    s_waitcnt lgkmcnt(8)
    ds_read_b128 v[240:243], v3 offset:45056
    v_mfma_f32_16x16x32_bf16 v[72:75], v[192:195], v[200:203], 0
    v_mfma_f32_16x16x32_bf16 v[76:79], v[192:195], v[204:207], 0
    buffer_load_dwordx4 v11, s[52:55], s34 offen offset:1024  lds
    ds_read_b128 v[244:247], v3 offset:46080
    v_mfma_f32_16x16x32_bf16 v[80:83], v[196:199], v[200:203], 0
    ds_read_b128 v[248:251], v4 offset:22528
    ds_read_b128 v[252:255], v4 offset:23552
    v_mfma_f32_16x16x32_bf16 v[84:87], v[196:199], v[204:207], 0
    v_mfma_f32_16x16x32_bf16 v[160:163], v[48:51], a[176:179], v[160:163]
    ds_read_b128 v[64:67], v35 offset:32768
    ds_read_b128 v[68:71], v35 offset:34816
    v_mfma_f32_16x16x32_bf16 v[168:171], v[48:51], a[180:183], v[168:171]
    buffer_load_dwordx4 v12, s[52:55], s34 offen offset:2048  lds
    v_mfma_f32_16x16x32_bf16 v[176:179], v[48:51], a[184:187], v[176:179]
    v_mfma_f32_16x16x32_bf16 v[184:187], v[48:51], a[188:191], v[184:187]
    s_waitcnt lgkmcnt(10)
    v_mfma_f32_16x16x32_bf16 v[72:75], v[208:211], v[216:219], v[72:75]
    v_mfma_f32_16x16x32_bf16 v[76:79], v[208:211], v[220:223], v[76:79]
    buffer_load_dwordx4 v13, s[52:55], s34 offen offset:3072  lds
    v_mfma_f32_16x16x32_bf16 v[80:83], v[212:215], v[216:219], v[80:83]
    v_mfma_f32_16x16x32_bf16 v[84:87], v[212:215], v[220:223], v[84:87]
    v_mfma_f32_16x16x32_bf16 v[132:135], v[52:55], a[160:163], v[132:135]
    v_mfma_f32_16x16x32_bf16 v[140:143], v[52:55], a[164:167], v[140:143]
    v_mfma_f32_16x16x32_bf16 v[148:151], v[52:55], a[168:171], v[148:151]
    v_mfma_f32_16x16x32_bf16 v[156:159], v[52:55], a[172:175], v[156:159]
    s_waitcnt lgkmcnt(6)
    v_mfma_f32_16x16x32_bf16 v[72:75], v[224:227], v[232:235], v[72:75]
    v_mfma_f32_16x16x32_bf16 v[76:79], v[224:227], v[236:239], v[76:79]
    v_mfma_f32_16x16x32_bf16 v[80:83], v[228:231], v[232:235], v[80:83]
    v_mfma_f32_16x16x32_bf16 v[84:87], v[228:231], v[236:239], v[84:87]
    v_mfma_f32_16x16x32_bf16 v[164:167], v[52:55], a[176:179], v[164:167]
    v_mfma_f32_16x16x32_bf16 v[172:175], v[52:55], a[180:183], v[172:175]
    v_mfma_f32_16x16x32_bf16 v[180:183], v[52:55], a[184:187], v[180:183]
    v_mfma_f32_16x16x32_bf16 v[188:191], v[52:55], a[188:191], v[188:191]
    s_waitcnt lgkmcnt(2)
    v_mfma_f32_16x16x32_bf16 v[72:75], v[240:243], v[248:251], v[72:75]
    v_mfma_f32_16x16x32_bf16 v[76:79], v[240:243], v[252:255], v[76:79]
    v_mfma_f32_16x16x32_bf16 v[80:83], v[244:247], v[248:251], v[80:83]
    v_mfma_f32_16x16x32_bf16 v[84:87], v[244:247], v[252:255], v[84:87]
    s_waitcnt lgkmcnt(15)
    v_mfma_f32_16x16x32_bf16 v[128:131], v[56:59], a[192:195], v[128:131]
    v_mfma_f32_16x16x32_bf16 v[132:135], v[60:63], a[192:195], v[132:135]
    s_waitcnt lgkmcnt(0)
    v_mfma_f32_16x16x32_bf16 v[128:131], v[64:67], a[224:227], v[128:131]
    s_add_u32 m0, s83, 98304
    s_add_u32 s34, s91, s87
    v_mfma_f32_16x16x32_bf16 v[132:135], v[68:71], a[224:227], v[132:135]
    buffer_load_dwordx4 v10, s[52:55], s34 offen offset:0  lds
    v_mfma_f32_16x16x32_bf16 v[136:139], v[56:59], a[196:199], v[136:139]
    s_waitcnt vmcnt(11)
    ds_read_b128 v[48:51], v34 offset:49152
    v_mfma_f32_16x16x32_bf16 v[140:143], v[60:63], a[196:199], v[140:143]
    ds_read_b128 v[52:55], v34 offset:51200
    v_mfma_f32_16x16x32_bf16 v[136:139], v[64:67], a[228:231], v[136:139]
    v_add_u32 v72, 0x8000, v72
    v_add_u32 v74, 0x8000, v74
    v_mfma_f32_16x16x32_bf16 v[140:143], v[68:71], a[228:231], v[140:143]
    buffer_load_dwordx4 v11, s[52:55], s34 offen offset:1024  lds
    v_add_u32 v76, 0x8000, v76
    v_mfma_f32_16x16x32_bf16 v[144:147], v[56:59], a[200:203], v[144:147]
    v_add_u32 v78, 0x8000, v78
    v_add_u32 v80, 0x8000, v80
    v_mfma_f32_16x16x32_bf16 v[148:151], v[60:63], a[200:203], v[148:151]
    v_add_u32 v82, 0x8000, v82
    v_add_u32 v84, 0x8000, v84
    v_mfma_f32_16x16x32_bf16 v[144:147], v[64:67], a[232:235], v[144:147]
    v_add_u32 v86, 0x8000, v86
    v_cvt_pk_bf16_f32 v72, v72, v73
    v_mfma_f32_16x16x32_bf16 v[148:151], v[68:71], a[232:235], v[148:151]
    buffer_load_dwordx4 v12, s[52:55], s34 offen offset:2048  lds
    v_cvt_pk_bf16_f32 v73, v74, v75
    v_mfma_f32_16x16x32_bf16 v[152:155], v[56:59], a[204:207], v[152:155]
    v_cvt_pk_bf16_f32 v74, v76, v77
    v_cvt_pk_bf16_f32 v75, v78, v79
    v_mfma_f32_16x16x32_bf16 v[156:159], v[60:63], a[204:207], v[156:159]
    v_cvt_pk_bf16_f32 v76, v80, v81
    v_cvt_pk_bf16_f32 v77, v82, v83
    v_mfma_f32_16x16x32_bf16 v[152:155], v[64:67], a[236:239], v[152:155]
    v_cvt_pk_bf16_f32 v78, v84, v85
    v_cvt_pk_bf16_f32 v79, v86, v87
    v_mfma_f32_16x16x32_bf16 v[156:159], v[68:71], a[236:239], v[156:159]
    buffer_load_dwordx4 v13, s[52:55], s34 offen offset:3072  lds
    v_and_or_b32 v72, v72, s78, v9
    v_mfma_f32_16x16x32_bf16 v[160:163], v[56:59], a[208:211], v[160:163]
    v_cvt_pk_bf16_f32 v128, v128, v129
    v_and_or_b32 v73, v73, s78, v9
    v_mfma_f32_16x16x32_bf16 v[164:167], v[60:63], a[208:211], v[164:167]
    v_cvt_pk_bf16_f32 v129, v130, v131
    v_and_or_b32 v74, v74, s78, v45
    v_mfma_f32_16x16x32_bf16 v[160:163], v[64:67], a[240:243], v[160:163]
    v_cvt_pk_bf16_f32 v130, v132, v133
    v_and_or_b32 v75, v75, s78, v45
    v_mfma_f32_16x16x32_bf16 v[164:167], v[68:71], a[240:243], v[164:167]
    v_and_or_b32 v76, v76, s78, v9
    v_and_or_b32 v77, v77, s78, v45
    v_and_or_b32 v78, v78, s78, v45
    v_and_or_b32 v79, v79, s78, v9
    v_mfma_f32_16x16x32_bf16 v[168:171], v[56:59], a[212:215], v[168:171]
    s_lshl_b32 s34, s99, 2
    s_add_u32 s34, s34, s68
    s_lshl_b32 s34, s34, 12
    s_add_u32 s34, s34, 12582912
    v_mfma_f32_16x16x32_bf16 v[172:175], v[60:63], a[212:215], v[172:175]
    buffer_store_dwordx4 v[72:75], v41, s[56:59], s34 offen offset:0 sc1
    v_cvt_pk_bf16_f32 v131, v134, v135
    v_mfma_f32_16x16x32_bf16 v[168:171], v[64:67], a[244:247], v[168:171]
    ds_write_b128 v2, v[128:131] offset:0
    v_cvt_pk_bf16_f32 v136, v136, v137
    v_mfma_f32_16x16x32_bf16 v[172:175], v[68:71], a[244:247], v[172:175]
    v_cvt_pk_bf16_f32 v137, v138, v139
    v_cvt_pk_bf16_f32 v138, v140, v141
    v_mfma_f32_16x16x32_bf16 v[176:179], v[56:59], a[216:219], v[176:179]
    v_cvt_pk_bf16_f32 v139, v142, v143
    ds_write_b128 v2, v[136:139] offset:1024
    v_mfma_f32_16x16x32_bf16 v[180:183], v[60:63], a[216:219], v[180:183]
    buffer_store_dwordx4 v[76:79], v41, s[56:59], s34 offen offset:2048 sc1
    v_cvt_pk_bf16_f32 v144, v144, v145
    v_mfma_f32_16x16x32_bf16 v[176:179], v[64:67], a[248:251], v[176:179]
    v_cvt_pk_bf16_f32 v145, v146, v147
    v_cvt_pk_bf16_f32 v146, v148, v149
    v_mfma_f32_16x16x32_bf16 v[180:183], v[68:71], a[248:251], v[180:183]
    v_cvt_pk_bf16_f32 v147, v150, v151
    ds_write_b128 v2, v[144:147] offset:2048
    v_mfma_f32_16x16x32_bf16 v[184:187], v[56:59], a[220:223], v[184:187]
    v_cvt_pk_bf16_f32 v152, v152, v153
    v_cvt_pk_bf16_f32 v153, v154, v155
    v_mfma_f32_16x16x32_bf16 v[188:191], v[60:63], a[220:223], v[188:191]
    v_cvt_pk_bf16_f32 v154, v156, v157
    v_cvt_pk_bf16_f32 v155, v158, v159
    v_mfma_f32_16x16x32_bf16 v[184:187], v[64:67], a[252:255], v[184:187]
    ds_write_b128 v2, v[152:155] offset:3072
    v_cvt_pk_bf16_f32 v160, v160, v161
    v_mfma_f32_16x16x32_bf16 v[188:191], v[68:71], a[252:255], v[188:191]
    s_waitcnt lgkmcnt(4)
    v_cvt_pk_bf16_f32 v161, v162, v163
    v_mfma_f32_16x16x32_bf16 v[192:195], v[48:51], a[0:3], 0
    v_cvt_pk_bf16_f32 v162, v164, v165
    v_cvt_pk_bf16_f32 v163, v166, v167
    v_mfma_f32_16x16x32_bf16 v[200:203], v[48:51], a[4:7], 0
    ds_write_b128 v2, v[160:163] offset:16384
    v_cvt_pk_bf16_f32 v168, v168, v169
    v_mfma_f32_16x16x32_bf16 v[208:211], v[48:51], a[8:11], 0
    v_cvt_pk_bf16_f32 v169, v170, v171
    v_cvt_pk_bf16_f32 v170, v172, v173
    v_mfma_f32_16x16x32_bf16 v[216:219], v[48:51], a[12:15], 0
    v_cvt_pk_bf16_f32 v171, v174, v175
    ds_write_b128 v2, v[168:171] offset:17408
    v_cvt_pk_bf16_f32 v176, v176, v177
    v_cvt_pk_bf16_f32 v177, v178, v179
    v_cvt_pk_bf16_f32 v178, v180, v181
    v_cvt_pk_bf16_f32 v179, v182, v183
    ds_write_b128 v2, v[176:179] offset:18432
    v_mfma_f32_16x16x32_bf16 v[224:227], v[48:51], a[16:19], 0
    ds_read_b128 v[56:59], v35 offset:49152
    ds_read_b128 v[60:63], v35 offset:51200
    v_mfma_f32_16x16x32_bf16 v[232:235], v[48:51], a[20:23], 0
    s_waitcnt vmcnt(12)
    v_mfma_f32_16x16x32_bf16 v[240:243], v[48:51], a[24:27], 0
    v_cvt_pk_bf16_f32 v184, v184, v185
    v_cvt_pk_bf16_f32 v185, v186, v187
    v_cvt_pk_bf16_f32 v186, v188, v189
    v_cvt_pk_bf16_f32 v187, v190, v191
    ds_write_b128 v2, v[184:187] offset:19456
    v_mfma_f32_16x16x32_bf16 v[248:251], v[48:51], a[28:31], 0
    s_waitcnt lgkmcnt(0)
    s_barrier
    v_mfma_f32_16x16x32_bf16 v[196:199], v[52:55], a[0:3], 0
    v_mfma_f32_16x16x32_bf16 v[204:207], v[52:55], a[4:7], 0
    ds_read_b128 v[128:131], v3 offset:0
    ds_read_b128 v[132:135], v3 offset:1024
    v_mfma_f32_16x16x32_bf16 v[212:215], v[52:55], a[8:11], 0
    v_mfma_f32_16x16x32_bf16 v[220:223], v[52:55], a[12:15], 0
    ds_read_b128 v[136:139], v4 offset:8192
    ds_read_b128 v[140:143], v4 offset:9216
    v_mfma_f32_16x16x32_bf16 v[228:231], v[52:55], a[16:19], 0
    v_mfma_f32_16x16x32_bf16 v[236:239], v[52:55], a[20:23], 0
    ds_read_b128 v[144:147], v3 offset:4096
    ds_read_b128 v[148:151], v3 offset:5120
    v_mfma_f32_16x16x32_bf16 v[244:247], v[52:55], a[24:27], 0
    v_mfma_f32_16x16x32_bf16 v[252:255], v[52:55], a[28:31], 0
    s_waitcnt lgkmcnt(2)
    ds_read_b128 v[152:155], v4 offset:10240
    v_mfma_f32_16x16x32_bf16 v[72:75], v[128:131], v[136:139], 0
    ds_read_b128 v[156:159], v4 offset:11264
    ds_read_b128 v[160:163], v3 offset:8192
    v_mfma_f32_16x16x32_bf16 v[76:79], v[128:131], v[140:143], 0
    v_mfma_f32_16x16x32_bf16 v[80:83], v[132:135], v[136:139], 0
    ds_read_b128 v[164:167], v3 offset:9216
    ds_read_b128 v[168:171], v4 offset:24576
    v_mfma_f32_16x16x32_bf16 v[84:87], v[132:135], v[140:143], 0
    s_waitcnt lgkmcnt(12)
    ds_read_b128 v[172:175], v4 offset:25600
    v_mfma_f32_16x16x32_bf16 v[192:195], v[56:59], a[32:35], v[192:195]
    s_waitcnt lgkmcnt(4)
    ds_read_b128 v[64:67], v36 offset:0
    v_mfma_f32_16x16x32_bf16 v[72:75], v[144:147], v[152:155], v[72:75]
    v_mfma_f32_16x16x32_bf16 v[76:79], v[144:147], v[156:159], v[76:79]
    ds_read_b128 v[68:71], v36 offset:2048
    ds_read_b128 v[176:179], v3 offset:12288
    v_mfma_f32_16x16x32_bf16 v[80:83], v[148:151], v[152:155], v[80:83]
    v_mfma_f32_16x16x32_bf16 v[84:87], v[148:151], v[156:159], v[84:87]
    ds_read_b128 v[180:183], v3 offset:13312
    ds_read_b128 v[184:187], v4 offset:26624
    v_mfma_f32_16x16x32_bf16 v[200:203], v[56:59], a[36:39], v[200:203]
    s_waitcnt lgkmcnt(5)
    ds_read_b128 v[188:191], v4 offset:27648
    v_mfma_f32_16x16x32_bf16 v[72:75], v[160:163], v[168:171], v[72:75]
    v_mfma_f32_16x16x32_bf16 v[76:79], v[160:163], v[172:175], v[76:79]
    ds_read_b128 v[48:51], v37 offset:0
    ds_read_b128 v[52:55], v37 offset:2048
    v_mfma_f32_16x16x32_bf16 v[80:83], v[164:167], v[168:171], v[80:83]
    s_lshl_b32 s34, s101, 2
    s_add_u32 s34, s34, s68
    s_lshl_b32 s34, s34, 12
    s_add_u32 s34, s34, 8388608
    v_mfma_f32_16x16x32_bf16 v[84:87], v[164:167], v[172:175], v[84:87]
    buffer_load_dwordx4 v[104:107], v41, s[56:59], s34 offen offset:0 sc1
    v_mfma_f32_16x16x32_bf16 v[208:211], v[56:59], a[40:43], v[208:211]
    s_waitcnt lgkmcnt(2)
    v_mfma_f32_16x16x32_bf16 v[72:75], v[176:179], v[184:187], v[72:75]
    buffer_load_dwordx4 v[108:111], v41, s[56:59], s34 offen offset:2048 sc1
    v_mfma_f32_16x16x32_bf16 v[76:79], v[176:179], v[188:191], v[76:79]
    v_mfma_f32_16x16x32_bf16 v[80:83], v[180:183], v[184:187], v[80:83]
    v_mfma_f32_16x16x32_bf16 v[84:87], v[180:183], v[188:191], v[84:87]
    v_mfma_f32_16x16x32_bf16 v[216:219], v[56:59], a[44:47], v[216:219]
    v_mfma_f32_16x16x32_bf16 v[224:227], v[56:59], a[48:51], v[224:227]
    v_mfma_f32_16x16x32_bf16 v[232:235], v[56:59], a[52:55], v[232:235]
    v_mfma_f32_16x16x32_bf16 v[240:243], v[56:59], a[56:59], v[240:243]
    v_mfma_f32_16x16x32_bf16 v[248:251], v[56:59], a[60:63], v[248:251]
    v_mfma_f32_16x16x32_bf16 v[196:199], v[60:63], a[32:35], v[196:199]
    v_mfma_f32_16x16x32_bf16 v[204:207], v[60:63], a[36:39], v[204:207]
    v_add_u32 v72, 0x8000, v72
    v_add_u32 v74, 0x8000, v74
    v_mfma_f32_16x16x32_bf16 v[212:215], v[60:63], a[40:43], v[212:215]
    v_add_u32 v76, 0x8000, v76
    v_add_u32 v78, 0x8000, v78
    v_mfma_f32_16x16x32_bf16 v[220:223], v[60:63], a[44:47], v[220:223]
    v_add_u32 v80, 0x8000, v80
    v_add_u32 v82, 0x8000, v82
    v_mfma_f32_16x16x32_bf16 v[228:231], v[60:63], a[48:51], v[228:231]
    v_add_u32 v84, 0x8000, v84
    v_add_u32 v86, 0x8000, v86
    v_mfma_f32_16x16x32_bf16 v[236:239], v[60:63], a[52:55], v[236:239]
    v_cvt_pk_bf16_f32 v72, v72, v73
    v_cvt_pk_bf16_f32 v73, v74, v75
    v_mfma_f32_16x16x32_bf16 v[244:247], v[60:63], a[56:59], v[244:247]
    v_cvt_pk_bf16_f32 v74, v76, v77
    v_cvt_pk_bf16_f32 v75, v78, v79
    v_mfma_f32_16x16x32_bf16 v[252:255], v[60:63], a[60:63], v[252:255]
    s_waitcnt lgkmcnt(6)
    v_cvt_pk_bf16_f32 v76, v80, v81
    v_mfma_f32_16x16x32_bf16 v[192:195], v[64:67], a[64:67], v[192:195]
    v_cvt_pk_bf16_f32 v77, v82, v83
    v_cvt_pk_bf16_f32 v78, v84, v85
    v_mfma_f32_16x16x32_bf16 v[200:203], v[64:67], a[68:71], v[200:203]
    v_cvt_pk_bf16_f32 v79, v86, v87
    v_and_or_b32 v72, v72, s78, v9
    v_mfma_f32_16x16x32_bf16 v[208:211], v[64:67], a[72:75], v[208:211]
    v_and_or_b32 v73, v73, s78, v9
    v_and_or_b32 v74, v74, s78, v45
    v_mfma_f32_16x16x32_bf16 v[216:219], v[64:67], a[76:79], v[216:219]
    v_and_or_b32 v75, v75, s78, v45
    v_and_or_b32 v76, v76, s78, v9
    v_mfma_f32_16x16x32_bf16 v[224:227], v[64:67], a[80:83], v[224:227]
    v_and_or_b32 v77, v77, s78, v45
    v_and_or_b32 v78, v78, s78, v45
    v_mfma_f32_16x16x32_bf16 v[232:235], v[64:67], a[84:87], v[232:235]
    v_and_or_b32 v79, v79, s78, v9
    s_waitcnt vmcnt(8)
    v_mfma_f32_16x16x32_bf16 v[240:243], v[64:67], a[88:91], v[240:243]
    ds_read_b128 v[56:59], v36 offset:16384
    ds_read_b128 v[60:63], v36 offset:18432
    v_mfma_f32_16x16x32_bf16 v[248:251], v[64:67], a[92:95], v[248:251]
    s_lshl_b32 s34, s100, 2
    s_add_u32 s34, s34, s68
    s_lshl_b32 s34, s34, 12
    s_add_u32 s34, s34, 16777216
    v_mfma_f32_16x16x32_bf16 v[196:199], v[68:71], a[64:67], v[196:199]
    buffer_store_dwordx4 v[72:75], v41, s[56:59], s34 offen offset:0 sc1
    ds_read_b128 v[144:147], v4 offset:12288
    v_mfma_f32_16x16x32_bf16 v[204:207], v[68:71], a[68:71], v[204:207]
    ds_read_b128 v[148:151], v4 offset:13312
    ds_read_b128 v[152:155], v4 offset:14336
    v_mfma_f32_16x16x32_bf16 v[212:215], v[68:71], a[72:75], v[212:215]
    buffer_store_dwordx4 v[76:79], v41, s[56:59], s34 offen offset:2048 sc1
    ds_read_b128 v[156:159], v4 offset:15360
    v_mfma_f32_16x16x32_bf16 v[220:223], v[68:71], a[76:79], v[220:223]
    v_mfma_f32_16x16x32_bf16 v[228:231], v[68:71], a[80:83], v[228:231]
    ds_read_b128 v[160:163], v4 offset:28672
    ds_read_b128 v[164:167], v4 offset:29696
    v_mfma_f32_16x16x32_bf16 v[236:239], v[68:71], a[84:87], v[236:239]
    v_mfma_f32_16x16x32_bf16 v[244:247], v[68:71], a[88:91], v[244:247]
    ds_read_b128 v[168:171], v4 offset:30720
    ds_read_b128 v[172:175], v4 offset:31744
    v_mfma_f32_16x16x32_bf16 v[252:255], v[68:71], a[92:95], v[252:255]
    s_waitcnt lgkmcnt(10)
    v_mfma_f32_16x16x32_bf16 v[192:195], v[48:51], a[96:99], v[192:195]
    v_mfma_f32_16x16x32_bf16 v[200:203], v[48:51], a[100:103], v[200:203]
    v_mfma_f32_16x16x32_bf16 v[208:211], v[48:51], a[104:107], v[208:211]
    v_mfma_f32_16x16x32_bf16 v[216:219], v[48:51], a[108:111], v[216:219]
    v_mfma_f32_16x16x32_bf16 v[224:227], v[48:51], a[112:115], v[224:227]
    ds_read_b128 v[64:67], v37 offset:16384
    ds_read_b128 v[68:71], v37 offset:18432
    v_mfma_f32_16x16x32_bf16 v[232:235], v[48:51], a[116:119], v[232:235]
    v_mfma_f32_16x16x32_bf16 v[240:243], v[48:51], a[120:123], v[240:243]
    v_mfma_f32_16x16x32_bf16 v[248:251], v[48:51], a[124:127], v[248:251]
    v_mfma_f32_16x16x32_bf16 v[196:199], v[52:55], a[96:99], v[196:199]
    v_mfma_f32_16x16x32_bf16 v[204:207], v[52:55], a[100:103], v[204:207]
    v_mfma_f32_16x16x32_bf16 v[212:215], v[52:55], a[104:107], v[212:215]
    v_mfma_f32_16x16x32_bf16 v[220:223], v[52:55], a[108:111], v[220:223]
    v_mfma_f32_16x16x32_bf16 v[228:231], v[52:55], a[112:115], v[228:231]
    v_mfma_f32_16x16x32_bf16 v[236:239], v[52:55], a[116:119], v[236:239]
    v_mfma_f32_16x16x32_bf16 v[244:247], v[52:55], a[120:123], v[244:247]
    v_mfma_f32_16x16x32_bf16 v[252:255], v[52:55], a[124:127], v[252:255]
    s_waitcnt lgkmcnt(10)
    v_mfma_f32_16x16x32_bf16 v[192:195], v[56:59], a[128:131], v[192:195]
    v_mfma_f32_16x16x32_bf16 v[200:203], v[56:59], a[132:135], v[200:203]
    v_mfma_f32_16x16x32_bf16 v[208:211], v[56:59], a[136:139], v[208:211]
    v_mfma_f32_16x16x32_bf16 v[216:219], v[56:59], a[140:143], v[216:219]
    v_mfma_f32_16x16x32_bf16 v[224:227], v[56:59], a[144:147], v[224:227]
    s_waitcnt vmcnt(6)
    ds_read_b128 v[48:51], v34 offset:32768
    v_mfma_f32_16x16x32_bf16 v[232:235], v[56:59], a[148:151], v[232:235]
    ds_read_b128 v[52:55], v34 offset:34816
    v_mfma_f32_16x16x32_bf16 v[240:243], v[56:59], a[152:155], v[240:243]
    v_mfma_f32_16x16x32_bf16 v[248:251], v[56:59], a[156:159], v[248:251]
    v_mfma_f32_16x16x32_bf16 v[196:199], v[60:63], a[128:131], v[196:199]
    v_mfma_f32_16x16x32_bf16 v[204:207], v[60:63], a[132:135], v[204:207]
    v_mfma_f32_16x16x32_bf16 v[212:215], v[60:63], a[136:139], v[212:215]
    v_mfma_f32_16x16x32_bf16 v[220:223], v[60:63], a[140:143], v[220:223]
    v_mfma_f32_16x16x32_bf16 v[228:231], v[60:63], a[144:147], v[228:231]
    v_mfma_f32_16x16x32_bf16 v[236:239], v[60:63], a[148:151], v[236:239]
    v_mfma_f32_16x16x32_bf16 v[244:247], v[60:63], a[152:155], v[244:247]
    v_mfma_f32_16x16x32_bf16 v[252:255], v[60:63], a[156:159], v[252:255]
    s_waitcnt lgkmcnt(2)
    v_mfma_f32_16x16x32_bf16 v[192:195], v[64:67], a[160:163], v[192:195]
    v_mfma_f32_16x16x32_bf16 v[200:203], v[64:67], a[164:167], v[200:203]
    v_mfma_f32_16x16x32_bf16 v[208:211], v[64:67], a[168:171], v[208:211]
    v_mfma_f32_16x16x32_bf16 v[216:219], v[64:67], a[172:175], v[216:219]
    v_mfma_f32_16x16x32_bf16 v[224:227], v[64:67], a[176:179], v[224:227]
    ds_read_b128 v[56:59], v35 offset:32768
    ds_read_b128 v[60:63], v35 offset:34816
    v_mfma_f32_16x16x32_bf16 v[232:235], v[64:67], a[180:183], v[232:235]
    v_mfma_f32_16x16x32_bf16 v[240:243], v[64:67], a[184:187], v[240:243]
    v_mfma_f32_16x16x32_bf16 v[248:251], v[64:67], a[188:191], v[248:251]
    v_mfma_f32_16x16x32_bf16 v[196:199], v[68:71], a[160:163], v[196:199]
    v_mfma_f32_16x16x32_bf16 v[204:207], v[68:71], a[164:167], v[204:207]
    v_mfma_f32_16x16x32_bf16 v[212:215], v[68:71], a[168:171], v[212:215]
    v_mfma_f32_16x16x32_bf16 v[220:223], v[68:71], a[172:175], v[220:223]
    v_mfma_f32_16x16x32_bf16 v[228:231], v[68:71], a[176:179], v[228:231]
    v_mfma_f32_16x16x32_bf16 v[236:239], v[68:71], a[180:183], v[236:239]
    v_mfma_f32_16x16x32_bf16 v[244:247], v[68:71], a[184:187], v[244:247]
    v_mfma_f32_16x16x32_bf16 v[252:255], v[68:71], a[188:191], v[252:255]
    s_waitcnt lgkmcnt(2)
    v_mfma_f32_16x16x32_bf16 v[192:195], v[48:51], a[192:195], v[192:195]
    s_waitcnt vmcnt(2)
    v_xor_b32 v104, v104, v9
    v_mfma_f32_16x16x32_bf16 v[196:199], v[52:55], a[192:195], v[196:199]
    s_waitcnt lgkmcnt(0)
    v_xor_b32 v105, v105, v9
    v_mfma_f32_16x16x32_bf16 v[192:195], v[56:59], a[224:227], v[192:195]
    v_xor_b32 v106, v106, v45
    v_xor_b32 v107, v107, v45
    v_mfma_f32_16x16x32_bf16 v[196:199], v[60:63], a[224:227], v[196:199]
    v_xor_b32 v108, v108, v9
    v_xor_b32 v109, v109, v45
    v_mfma_f32_16x16x32_bf16 v[200:203], v[48:51], a[196:199], v[200:203]
    v_xor_b32 v110, v110, v45
    v_xor_b32 v111, v111, v9
    v_mfma_f32_16x16x32_bf16 v[204:207], v[52:55], a[196:199], v[204:207]
    v_or_b32 v44, v104, v105
    v_or3_b32 v44, v106, v107, v44
    v_mfma_f32_16x16x32_bf16 v[200:203], v[56:59], a[228:231], v[200:203]
    v_or3_b32 v44, v108, v109, v44
    v_or3_b32 v44, v110, v111, v44
    v_mfma_f32_16x16x32_bf16 v[204:207], v[60:63], a[228:231], v[204:207]
    v_and_b32 v44, 1, v44
    v_cmp_ne_u32 vcc, 0, v44
    s_nop 1
    s_cmp_eq_u64 vcc, 0
    s_cbranch_scc0 L_slow2
L_ok2:
    v_mfma_f32_16x16x32_bf16 v[208:211], v[48:51], a[200:203], v[208:211]
    v_lshlrev_b32 v88, 16, v104
    v_and_b32 v89, 0xffff0000, v104
    v_mfma_f32_16x16x32_bf16 v[212:215], v[52:55], a[200:203], v[212:215]
    v_lshlrev_b32 v90, 16, v105
    v_and_b32 v91, 0xffff0000, v105
    v_mfma_f32_16x16x32_bf16 v[208:211], v[56:59], a[232:235], v[208:211]
    v_cvt_pk_bf16_f32 v192, v192, v193
    v_cvt_pk_bf16_f32 v193, v194, v195
    v_mfma_f32_16x16x32_bf16 v[212:215], v[60:63], a[232:235], v[212:215]
    v_cvt_pk_bf16_f32 v194, v196, v197
    v_cvt_pk_bf16_f32 v195, v198, v199
    v_mfma_f32_16x16x32_bf16 v[216:219], v[48:51], a[204:207], v[216:219]
    ds_write_b128 v2, v[192:195] offset:32768
    v_lshlrev_b32 v92, 16, v106
    v_mfma_f32_16x16x32_bf16 v[220:223], v[52:55], a[204:207], v[220:223]
    v_and_b32 v93, 0xffff0000, v106
    v_lshlrev_b32 v94, 16, v107
    v_mfma_f32_16x16x32_bf16 v[216:219], v[56:59], a[236:239], v[216:219]
    v_cvt_pk_bf16_f32 v200, v200, v201
    v_cvt_pk_bf16_f32 v201, v202, v203
    v_mfma_f32_16x16x32_bf16 v[220:223], v[60:63], a[236:239], v[220:223]
L_pad4:
    s_cbranch_execz L_warm1
    v_cvt_pk_bf16_f32 v202, v204, v205
    v_cvt_pk_bf16_f32 v203, v206, v207
    v_mfma_f32_16x16x32_bf16 v[224:227], v[48:51], a[208:211], v[224:227]
    ds_write_b128 v2, v[200:203] offset:33792
    v_and_b32 v95, 0xffff0000, v107
    v_mfma_f32_16x16x32_bf16 v[228:231], v[52:55], a[208:211], v[228:231]
    v_lshlrev_b32 v96, 16, v108
    v_and_b32 v97, 0xffff0000, v108
    v_mfma_f32_16x16x32_bf16 v[224:227], v[56:59], a[240:243], v[224:227]
    v_cvt_pk_bf16_f32 v208, v208, v209
    v_cvt_pk_bf16_f32 v209, v210, v211
    v_mfma_f32_16x16x32_bf16 v[228:231], v[60:63], a[240:243], v[228:231]
    v_cvt_pk_bf16_f32 v210, v212, v213
    v_cvt_pk_bf16_f32 v211, v214, v215
    v_mfma_f32_16x16x32_bf16 v[232:235], v[48:51], a[212:215], v[232:235]
    ds_write_b128 v2, v[208:211] offset:34816
    v_lshlrev_b32 v98, 16, v109
    v_mfma_f32_16x16x32_bf16 v[236:239], v[52:55], a[212:215], v[236:239]
    v_and_b32 v99, 0xffff0000, v109
    v_lshlrev_b32 v100, 16, v110
    v_mfma_f32_16x16x32_bf16 v[232:235], v[56:59], a[244:247], v[232:235]
    v_cvt_pk_bf16_f32 v216, v216, v217
    v_cvt_pk_bf16_f32 v217, v218, v219
    v_mfma_f32_16x16x32_bf16 v[236:239], v[60:63], a[244:247], v[236:239]
    v_cvt_pk_bf16_f32 v218, v220, v221
    v_cvt_pk_bf16_f32 v219, v222, v223
    v_mfma_f32_16x16x32_bf16 v[240:243], v[48:51], a[216:219], v[240:243]
    ds_write_b128 v2, v[216:219] offset:35840
    v_and_b32 v101, 0xffff0000, v110
    v_mfma_f32_16x16x32_bf16 v[244:247], v[52:55], a[216:219], v[244:247]
    v_lshlrev_b32 v102, 16, v111
    v_and_b32 v103, 0xffff0000, v111
    v_mfma_f32_16x16x32_bf16 v[240:243], v[56:59], a[248:251], v[240:243]
    v_cvt_pk_bf16_f32 v224, v224, v225
    v_cvt_pk_bf16_f32 v225, v226, v227
    v_mfma_f32_16x16x32_bf16 v[244:247], v[60:63], a[248:251], v[244:247]
    v_cvt_pk_bf16_f32 v226, v228, v229
    v_cvt_pk_bf16_f32 v227, v230, v231
    v_mfma_f32_16x16x32_bf16 v[248:251], v[48:51], a[220:223], v[248:251]
    ds_write_b128 v2, v[224:227] offset:49152
    v_mfma_f32_16x16x32_bf16 v[252:255], v[52:55], a[220:223], v[252:255]
    v_mfma_f32_16x16x32_bf16 v[248:251], v[56:59], a[252:255], v[248:251]
    v_mfma_f32_16x16x32_bf16 v[252:255], v[60:63], a[252:255], v[252:255]
    s_lshl_b32 s34, s101, 2
    s_add_u32 s34, s34, s68
    s_lshl_b32 s34, s34, 12
    s_add_u32 s34, s34, 12582912
    buffer_load_dwordx4 v[112:115], v41, s[56:59], s34 offen offset:0 sc1
    buffer_load_dwordx4 v[116:119], v41, s[56:59], s34 offen offset:2048 sc1
    s_lshl_b32 s34, s101, 2
    s_add_u32 s34, s34, s68
    s_lshl_b32 s34, s34, 12
    s_add_u32 s34, s34, 16777216
    buffer_load_dwordx4 v[128:131], v41, s[56:59], s34 offen offset:0 sc1
    buffer_load_dwordx4 v[132:135], v41, s[56:59], s34 offen offset:2048 sc1
    v_cvt_pk_bf16_f32 v232, v232, v233
    v_cvt_pk_bf16_f32 v233, v234, v235
    v_cvt_pk_bf16_f32 v234, v236, v237
    v_cvt_pk_bf16_f32 v235, v238, v239
    ds_write_b128 v2, v[232:235] offset:50176
    v_cvt_pk_bf16_f32 v240, v240, v241
    v_cvt_pk_bf16_f32 v241, v242, v243
    v_cvt_pk_bf16_f32 v242, v244, v245
    v_cvt_pk_bf16_f32 v243, v246, v247
    ds_write_b128 v2, v[240:243] offset:51200
    v_cvt_pk_bf16_f32 v248, v248, v249
    v_cvt_pk_bf16_f32 v249, v250, v251
    v_cvt_pk_bf16_f32 v250, v252, v253
    v_cvt_pk_bf16_f32 v251, v254, v255
    ds_write_b128 v2, v[248:251] offset:52224
    s_waitcnt lgkmcnt(0)
    s_barrier
    ds_read_b128 v[192:195], v3 offset:32768
    ds_read_b128 v[196:199], v3 offset:33792
    ds_read_b128 v[208:211], v3 offset:36864
    ds_read_b128 v[212:215], v3 offset:37888
    ds_read_b128 v[224:227], v3 offset:40960
    ds_read_b128 v[228:231], v3 offset:41984
    ds_read_b128 v[240:243], v3 offset:45056
    ds_read_b128 v[244:247], v3 offset:46080
    s_waitcnt lgkmcnt(6)
    v_mfma_f32_16x16x32_bf16 v[72:75], v[192:195], v[144:147], v[88:91]
    v_mfma_f32_16x16x32_bf16 v[76:79], v[192:195], v[148:151], v[92:95]
    v_mfma_f32_16x16x32_bf16 v[80:83], v[196:199], v[144:147], v[96:99]
    v_mfma_f32_16x16x32_bf16 v[84:87], v[196:199], v[148:151], v[100:103]
    s_waitcnt lgkmcnt(4)
    v_mfma_f32_16x16x32_bf16 v[72:75], v[208:211], v[152:155], v[72:75]
    v_mfma_f32_16x16x32_bf16 v[76:79], v[208:211], v[156:159], v[76:79]
    v_mfma_f32_16x16x32_bf16 v[80:83], v[212:215], v[152:155], v[80:83]
    v_mfma_f32_16x16x32_bf16 v[84:87], v[212:215], v[156:159], v[84:87]
    s_waitcnt lgkmcnt(2)
    v_mfma_f32_16x16x32_bf16 v[72:75], v[224:227], v[160:163], v[72:75]
    v_mfma_f32_16x16x32_bf16 v[76:79], v[224:227], v[164:167], v[76:79]
    v_mfma_f32_16x16x32_bf16 v[80:83], v[228:231], v[160:163], v[80:83]
    v_mfma_f32_16x16x32_bf16 v[84:87], v[228:231], v[164:167], v[84:87]
    s_waitcnt lgkmcnt(0)
    v_mfma_f32_16x16x32_bf16 v[72:75], v[240:243], v[168:171], v[72:75]
    v_mfma_f32_16x16x32_bf16 v[76:79], v[240:243], v[172:175], v[76:79]
    v_mfma_f32_16x16x32_bf16 v[80:83], v[244:247], v[168:171], v[80:83]
    v_mfma_f32_16x16x32_bf16 v[84:87], v[244:247], v[172:175], v[84:87]
    s_waitcnt vmcnt(0)
    v_xor_b32 v112, v112, v9
    v_xor_b32 v113, v113, v9
    v_xor_b32 v114, v114, v45
    v_xor_b32 v115, v115, v45
    v_xor_b32 v116, v116, v9
    v_xor_b32 v117, v117, v45
    v_xor_b32 v118, v118, v45
    v_xor_b32 v119, v119, v9
    v_xor_b32 v128, v128, v9
    v_xor_b32 v129, v129, v9
    v_xor_b32 v130, v130, v45
    v_xor_b32 v131, v131, v45
    v_xor_b32 v132, v132, v9
    v_xor_b32 v133, v133, v45
    v_xor_b32 v134, v134, v45
    v_xor_b32 v135, v135, v9
    v_or_b32 v44, v112, v113
    v_or3_b32 v44, v114, v115, v44
    v_or3_b32 v44, v116, v117, v44
    v_or3_b32 v44, v118, v119, v44
    v_or3_b32 v44, v128, v129, v44
    v_or3_b32 v44, v130, v131, v44
    v_or3_b32 v44, v132, v133, v44
    v_or3_b32 v44, v134, v135, v44
    v_and_b32 v44, 1, v44
    v_cmp_ne_u32 vcc, 0, v44
    s_nop 1
    s_cmp_eq_u64 vcc, 0
    s_cbranch_scc0 L_slow3
L_ok3:
    s_mov_b32 s73, 28672
    s_nop 2
    v_dot2_f32_bf16 v72, v112, s81, v72
    v_dot2_f32_bf16 v73, v112, s82, v73
    v_dot2_f32_bf16 v74, v113, s81, v74
    v_dot2_f32_bf16 v75, v113, s82, v75
    v_dot2_f32_bf16 v76, v114, s81, v76
    v_dot2_f32_bf16 v77, v114, s82, v77
    v_dot2_f32_bf16 v78, v115, s81, v78
    v_dot2_f32_bf16 v79, v115, s82, v79
    v_dot2_f32_bf16 v80, v116, s81, v80
    v_dot2_f32_bf16 v81, v116, s82, v81
    v_dot2_f32_bf16 v82, v117, s81, v82
    v_dot2_f32_bf16 v83, v117, s82, v83
    v_dot2_f32_bf16 v84, v118, s81, v84
    v_dot2_f32_bf16 v85, v118, s82, v85
    v_dot2_f32_bf16 v86, v119, s81, v86
    v_dot2_f32_bf16 v87, v119, s82, v87
    v_dot2_f32_bf16 v72, v128, s81, v72
    v_dot2_f32_bf16 v73, v128, s82, v73
    v_dot2_f32_bf16 v74, v129, s81, v74
    v_dot2_f32_bf16 v75, v129, s82, v75
    v_dot2_f32_bf16 v76, v130, s81, v76
    v_dot2_f32_bf16 v77, v130, s82, v77
    v_dot2_f32_bf16 v78, v131, s81, v78
    v_dot2_f32_bf16 v79, v131, s82, v79
    v_dot2_f32_bf16 v80, v132, s81, v80
    v_dot2_f32_bf16 v81, v132, s82, v81
    v_dot2_f32_bf16 v82, v133, s81, v82
    v_dot2_f32_bf16 v83, v133, s82, v83
    v_dot2_f32_bf16 v84, v134, s81, v84
    v_dot2_f32_bf16 v85, v134, s82, v85
    v_dot2_f32_bf16 v86, v135, s81, v86
    v_dot2_f32_bf16 v87, v135, s82, v87
    s_nop 2
    v_cvt_pk_bf16_f32 v72, v72, v73
    v_cvt_pk_bf16_f32 v73, v74, v75
    v_cvt_pk_bf16_f32 v74, v80, v81
    v_cvt_pk_bf16_f32 v75, v82, v83
    v_cvt_pk_bf16_f32 v76, v76, v77
    v_cvt_pk_bf16_f32 v77, v78, v79
    v_cvt_pk_bf16_f32 v78, v84, v85
    v_cvt_pk_bf16_f32 v79, v86, v87
    v_permlane16_swap_b32 v72, v74
    v_permlane16_swap_b32 v73, v75
    buffer_store_dwordx4 v[72:75], v8, s[60:63], 0 offen
    v_permlane16_swap_b32 v76, v78
    v_permlane16_swap_b32 v77, v79
    buffer_store_dwordx4 v[76:79], v8, s[60:63], s73 offen
L_end:
    s_endpgm
L_slow1:
    s_mov_b32 s75, 0
L_spin1:
    buffer_load_dwordx4 v[88:91], v0, s[56:59], s96 offen offset:0 sc1
    buffer_load_dwordx4 v[92:95], v0, s[56:59], s96 offen offset:2048 sc1
    buffer_load_dwordx4 v[96:99], v0, s[56:59], s77 offen offset:0 sc1
    buffer_load_dwordx4 v[100:103], v0, s[56:59], s77 offen offset:2048 sc1
    buffer_load_dwordx4 v[104:107], v0, s[56:59], s80 offen offset:0 sc1
    buffer_load_dwordx4 v[108:111], v0, s[56:59], s80 offen offset:2048 sc1
    buffer_load_dwordx4 v[112:115], v0, s[56:59], s94 offen offset:0 sc1
    buffer_load_dwordx4 v[116:119], v0, s[56:59], s94 offen offset:2048 sc1
    s_waitcnt vmcnt(0)
    v_xor_b32 v88, v88, v47
    v_xor_b32 v89, v89, v47
    v_xor_b32 v90, v90, v46
    v_xor_b32 v91, v91, v46
    v_xor_b32 v92, v92, v47
    v_xor_b32 v93, v93, v46
    v_xor_b32 v94, v94, v46
    v_xor_b32 v95, v95, v47
    v_xor_b32 v96, v96, v47
    v_xor_b32 v97, v97, v47
    v_xor_b32 v98, v98, v46
    v_xor_b32 v99, v99, v46
    v_xor_b32 v100, v100, v47
    v_xor_b32 v101, v101, v46
    v_xor_b32 v102, v102, v46
    v_xor_b32 v103, v103, v47
    v_xor_b32 v104, v104, v47
    v_xor_b32 v105, v105, v47
    v_xor_b32 v106, v106, v46
    v_xor_b32 v107, v107, v46
    v_xor_b32 v108, v108, v47
    v_xor_b32 v109, v109, v46
    v_xor_b32 v110, v110, v46
    v_xor_b32 v111, v111, v47
    v_xor_b32 v112, v112, v47
    v_xor_b32 v113, v113, v47
    v_xor_b32 v114, v114, v46
    v_xor_b32 v115, v115, v46
    v_xor_b32 v116, v116, v47
    v_xor_b32 v117, v117, v46
    v_xor_b32 v118, v118, v46
    v_xor_b32 v119, v119, v47
    v_or_b32 v44, v88, v89
    v_or3_b32 v44, v90, v91, v44
    v_or3_b32 v44, v92, v93, v44
    v_or3_b32 v44, v94, v95, v44
    v_or3_b32 v44, v96, v97, v44
    v_or3_b32 v44, v98, v99, v44
    v_or3_b32 v44, v100, v101, v44
    v_or3_b32 v44, v102, v103, v44
    v_or3_b32 v44, v104, v105, v44
    v_or3_b32 v44, v106, v107, v44
    v_or3_b32 v44, v108, v109, v44
    v_or3_b32 v44, v110, v111, v44
    v_or3_b32 v44, v112, v113, v44
    v_or3_b32 v44, v114, v115, v44
    v_or3_b32 v44, v116, v117, v44
    v_or3_b32 v44, v118, v119, v44
    v_and_b32 v44, 0x8000, v44
    v_cmp_ne_u32 vcc, 0, v44
    s_nop 1
    s_cmp_eq_u64 vcc, 0
    s_cbranch_scc1 L_ok1
    s_add_u32 s75, s75, 1
    s_cmp_lt_u32 s75, 0x40000
    s_cbranch_scc1 L_spin1
    s_branch L_ok1
L_slow2:
    s_mov_b32 s75, 0
L_spin2:
    s_lshl_b32 s73, s101, 2
    s_add_u32 s73, s73, s68
    s_lshl_b32 s73, s73, 12
    s_add_u32 s73, s73, 8388608
    buffer_load_dwordx4 v[104:107], v41, s[56:59], s73 offen offset:0 sc1
    buffer_load_dwordx4 v[108:111], v41, s[56:59], s73 offen offset:2048 sc1
    s_waitcnt vmcnt(0)
    v_xor_b32 v104, v104, v9
    v_xor_b32 v105, v105, v9
    v_xor_b32 v106, v106, v45
    v_xor_b32 v107, v107, v45
    v_xor_b32 v108, v108, v9
    v_xor_b32 v109, v109, v45
    v_xor_b32 v110, v110, v45
    v_xor_b32 v111, v111, v9
    v_or_b32 v44, v104, v105
    v_or3_b32 v44, v106, v107, v44
    v_or3_b32 v44, v108, v109, v44
    v_or3_b32 v44, v110, v111, v44
    v_and_b32 v44, 1, v44
    v_cmp_ne_u32 vcc, 0, v44
    s_nop 1
    s_cmp_eq_u64 vcc, 0
    s_cbranch_scc1 L_ok2
    s_add_u32 s75, s75, 1
    s_cmp_lt_u32 s75, 0x40000
    s_cbranch_scc1 L_spin2
    s_branch L_ok2
L_slow3:
    s_mov_b32 s75, 0
L_spin3:
    s_lshl_b32 s73, s101, 2
    s_add_u32 s73, s73, s68
    s_lshl_b32 s73, s73, 12
    s_add_u32 s73, s73, 12582912
    buffer_load_dwordx4 v[112:115], v41, s[56:59], s73 offen offset:0 sc1
    buffer_load_dwordx4 v[116:119], v41, s[56:59], s73 offen offset:2048 sc1
    s_lshl_b32 s73, s101, 2
    s_add_u32 s73, s73, s68
    s_lshl_b32 s73, s73, 12
    s_add_u32 s73, s73, 16777216
    buffer_load_dwordx4 v[128:131], v41, s[56:59], s73 offen offset:0 sc1
    buffer_load_dwordx4 v[132:135], v41, s[56:59], s73 offen offset:2048 sc1
    s_waitcnt vmcnt(0)
    v_xor_b32 v112, v112, v9
    v_xor_b32 v113, v113, v9
    v_xor_b32 v114, v114, v45
    v_xor_b32 v115, v115, v45
    v_xor_b32 v116, v116, v9
    v_xor_b32 v117, v117, v45
    v_xor_b32 v118, v118, v45
    v_xor_b32 v119, v119, v9
    v_xor_b32 v128, v128, v9
    v_xor_b32 v129, v129, v9
    v_xor_b32 v130, v130, v45
    v_xor_b32 v131, v131, v45
    v_xor_b32 v132, v132, v9
    v_xor_b32 v133, v133, v45
    v_xor_b32 v134, v134, v45
    v_xor_b32 v135, v135, v9
    v_or_b32 v44, v112, v113
    v_or3_b32 v44, v114, v115, v44
    v_or3_b32 v44, v116, v117, v44
    v_or3_b32 v44, v118, v119, v44
    v_or3_b32 v44, v128, v129, v44
    v_or3_b32 v44, v130, v131, v44
    v_or3_b32 v44, v132, v133, v44
    v_or3_b32 v44, v134, v135, v44
    v_and_b32 v44, 1, v44
    v_cmp_ne_u32 vcc, 0, v44
    s_nop 1
    s_cmp_eq_u64 vcc, 0
    s_cbranch_scc1 L_ok3
    s_add_u32 s75, s75, 1
    s_cmp_lt_u32 s75, 0x40000
    s_cbranch_scc1 L_spin3
    s_branch L_ok3
.section .rodata,"a"
.p2align 6
.amdhsa_kernel concat_heads__gqa_block_cached__mha_block_cached__near_ridge_kernel
  .amdhsa_next_free_vgpr 512
  .amdhsa_next_free_sgpr 102
  .amdhsa_accum_offset 256
  .amdhsa_group_segment_fixed_size 0
  .amdhsa_kernarg_size 104
  .amdhsa_user_sgpr_count 2
  .amdhsa_user_sgpr_kernarg_segment_ptr 1
  .amdhsa_system_sgpr_workgroup_id_x 1
  .amdhsa_float_denorm_mode_32 3
.end_amdhsa_kernel
```
